```python
import torch

def _softmax(x, axis=-1):
    return torch.softmax(x, dim=axis)
def _gelu(x):
    return torch.nn.functional.gelu(x, approximate="tanh")
def _silu(x):
    return torch.nn.functional.silu(x)
def _sigmoid(x):
    return torch.sigmoid(x)
def _layernorm(x, axis=-1, eps=1e-5):
    m = x.mean(dim=axis, keepdim=True)
    v = x.var(dim=axis, keepdim=True, unbiased=False)
    return (x - m) / torch.sqrt(v + eps)
def _scatter_add(tgt, idx, src, axis=0):
    return tgt.clone().index_add_(axis, idx, src)
def _segment_sum(src, seg, n):
    out = torch.zeros((n,) + src.shape[1:], dtype=src.dtype)
    return out.index_add_(0, seg, src)
def _pad(x, pw):
    flat = tuple(v for pair in reversed(pw) for v in pair)
    return torch.nn.functional.pad(x, flat)

kernel_name = 'standalone__weight_only_int_quip__prompt'

def setup_inputs():

    _w = (lambda a: (lambda t: t.to(torch.bfloat16) if t.is_floating_point() else t)(torch.as_tensor(a)))
    B, S, D, F = 1, 2048, 1024, 3584
    G = 32 if 32 > 0 else D
    D = (D // G) * G
    ng = D // G
    bits = 8 if 8 > 0 else 4
    qmax = 1 << bits
    qw = torch.randint(0, qmax, (D, F)).to(torch.int32)
    U, _ = (lambda *_a, **_k: torch.linalg.qr(*[torch.as_tensor(_x).float() for _x in _a], **_k))((lambda *s: torch.randn(*s, dtype=torch.bfloat16) * 0.05)(D, D))
    V, _ = (lambda *_a, **_k: torch.linalg.qr(*[torch.as_tensor(_x).float() for _x in _a], **_k))((lambda *s: torch.randn(*s, dtype=torch.bfloat16) * 0.05)(F, F))
    return {
        "x": _w((lambda *s: torch.randn(*s, dtype=torch.bfloat16) * 0.05)(B, S, D)),
        "qw": _w(qw),
        "scales": _w(torch.abs((lambda *s: torch.randn(*s, dtype=torch.bfloat16) * 0.05)(ng, F)) * 0.02 + 0.005),
        "zeros": _w(torch.full((ng, F), qmax / 2.0, dtype=float)),
        "U": _w(U.to(float)),
        "V": _w(V.to(float)),
    }

def reference(x, qw, scales, zeros, U, V):
    B, S, D = x.shape
    ng, F = scales.shape
    G = D // ng
    s = (lambda x, n, axis: torch.repeat_interleave(x, n, dim=axis))(scales, G, axis=0)
    z = (lambda x, n, axis: torch.repeat_interleave(x, n, dim=axis))(zeros, G, axis=0)
    wq = ((lambda x, dt: x.to(dt))(qw, x.dtype) - z) * s
    xr = torch.einsum("bsd,de->bse", x, U)
    h  = torch.einsum("bse,ef->bsf", xr, wq)
    y  = torch.einsum("bsf,fg->bsg", h, V)
    return y
```

```asm
; @launch grid=(256,1,1) block=(512,1,1) lds=147456
.amdgcn_target "amdgcn-amd-amdhsa--gfx950"
.text
.globl standalone__weight_only_int_quip__prompt_kernel
.p2align 8
.type standalone__weight_only_int_quip__prompt_kernel,@function
standalone__weight_only_int_quip__prompt_kernel:
    s_load_dwordx16 s[60:75], s[0:1], 0
    s_load_dwordx2 s[56:57], s[0:1], 64
    s_cmp_ge_u32 s2, 256
    s_cbranch_scc1 L_end
    s_and_b32 s20, s2, 7
    s_lshr_b32 s21, s2, 3
    v_lshrrev_b32 v1, 6, v0
    v_and_b32 v2, 63, v0
    s_nop 0
    v_readfirstlane_b32 s25, v1
    s_and_b32 s26, s21, 3
    s_lshl_b32 s22, s26, 1
    s_and_b32 s23, s20, 1
    s_add_u32 s22, s22, s23
    s_lshr_b32 s23, s20, 1
    s_mul_i32 s23, s23, 7
    s_lshr_b32 s24, s21, 2
    s_add_u32 s23, s23, s24
    s_add_u32 s24, s26, s23
    s_and_b32 s24, s24, 3
    s_mov_b32 s33, 0
    s_mov_b32 s26, 27357184
    s_waitcnt lgkmcnt(0)
    s_load_dwordx2 s[6:7], s[56:57], s26
    s_add_u32 s48, s56, 27262976
    s_addc_u32 s49, s57, 0
    s_mov_b32 s50, 94336
    s_mov_b32 s51, 0x20000
    s_cmp_ge_u32 s21, 28
    s_cbranch_scc1 L_spare
    s_mov_b32 s40, s62
    s_mov_b32 s41, s63
    s_mov_b32 s42, 14680064
    s_mov_b32 s43, 0x20000
    s_mov_b32 s76, s64
    s_mov_b32 s77, s65
    s_mov_b32 s78, 229376
    s_mov_b32 s79, 0x20000
    s_mov_b32 s16, s66
    s_mov_b32 s17, s67
    s_mov_b32 s18, 229376
    s_mov_b32 s19, 0x20000
    v_lshrrev_b32 v3, 3, v2
    v_and_b32 v4, 7, v2
    v_mul_u32_u24 v5, 14336, v3
    v_lshlrev_b32 v6, 4, v4
    v_add_u32 v21, v5, v6
    v_lshlrev_b32 v22, 3, v4
    s_and_b32 s38, s20, 1
    s_mul_i32 s38, s38, 25
    s_lshr_b32 s35, s23, 1
    s_add_u32 s38, s38, s35
    s_mov_b32 s39, s25
    s_and_b32 s47, s22, 6
    s_and_b32 s35, s23, 1
    s_or_b32 s47, s47, s35
    s_lshl_b32 s26, s47, 3
    s_add_u32 s26, s26, s39
    s_mul_i32 s27, s26, 229376
    s_lshl_b32 s35, s38, 8
    s_add_u32 s27, s27, s35
    s_lshr_b32 s26, s26, 1
    s_mul_i32 s26, s26, 7168
    s_lshl_b32 s35, s38, 7
    s_add_u32 s26, s26, s35
    buffer_load_dwordx4 v[160:163], v21, s[40:43], s27 offen offset:0
    buffer_load_dwordx4 v[164:167], v21, s[40:43], s27 offen offset:128
    buffer_load_dwordx2 v[192:193], v22, s[76:79], s26 offen offset:0
    buffer_load_dwordx2 v[196:197], v22, s[16:19], s26 offen offset:0
    buffer_load_dwordx2 v[194:195], v22, s[76:79], s26 offen offset:64
    buffer_load_dwordx2 v[198:199], v22, s[16:19], s26 offen offset:64
    s_add_u32 s27, s27, 114688
    buffer_load_dwordx4 v[168:171], v21, s[40:43], s27 offen offset:0
    buffer_load_dwordx4 v[172:175], v21, s[40:43], s27 offen offset:128
    s_mul_i32 s47, s47, 56
    s_add_u32 s47, s47, s38
    s_lshl_b32 s47, s47, 14
    s_lshl_b32 s39, s39, 10
    s_add_u32 s47, s47, s39
    v_lshrrev_b32 v1, 2, v4
    v_lshlrev_b32 v1, 13, v1
    v_and_b32 v6, 3, v4
    v_lshlrev_b32 v6, 8, v6
    v_lshlrev_b32 v3, 4, v3
    v_add3_u32 v1, v1, v6, v3
    s_mov_b32 s12, s56
    s_mov_b32 s13, s57
    s_mov_b32 s14, 7340032
    s_mov_b32 s15, 0x20000
    s_cmp_ge_u32 s25, 4
    s_cbranch_scc1 L_mainp
    s_lshr_b32 s30, s25, 1
    s_and_b32 s31, s25, 1
    v_lshrrev_b32 v3, 4, v2
    v_and_b32 v4, 15, v2
    v_lshrrev_b32 v5, 2, v4
    v_and_b32 v6, 3, v4
    v_lshlrev_b32 v7, 2, v3
    v_add_u32 v7, v7, v5
    v_lshlrev_b32 v7, 8, v7
    v_lshlrev_b32 v6, 3, v6
    v_add_u32 v7, v7, v6
    v_and_b32 v6, 1, v3
    v_lshlrev_b32 v6, 2, v6
    v_or_b32 v6, v6, v5
    s_lshl_b32 s26, s31, 2
    v_xor_b32 v6, s26, v6
    v_xor_b32 v5, 0, v6
    v_lshlrev_b32 v5, 5, v5
    v_add_u32 v16, v7, v5
    v_xor_b32 v5, 1, v6
    v_lshlrev_b32 v5, 5, v5
    v_add_u32 v17, v7, v5
    v_xor_b32 v5, 2, v6
    v_lshlrev_b32 v5, 5, v5
    v_add_u32 v18, v7, v5
    v_xor_b32 v5, 3, v6
    v_lshlrev_b32 v5, 5, v5
    v_add_u32 v19, v7, v5
    s_lshl_b32 s26, s30, 12
    s_add_u32 s26, s26, 16384
    v_lshlrev_b32 v5, 4, v2
    v_add_u32 v20, s26, v5
    v_mov_b64 v[28:29], 0
    v_mov_b64 v[30:31], 0
    v_mov_b64 v[32:33], 0
    v_mov_b64 v[34:35], 0
    v_mov_b64 v[36:37], 0
    v_mov_b64 v[38:39], 0
    v_mov_b64 v[40:41], 0
    v_mov_b64 v[42:43], 0
    v_mov_b64 v[44:45], 0
    v_mov_b64 v[46:47], 0
    v_mov_b64 v[48:49], 0
    v_mov_b64 v[50:51], 0
    v_mov_b64 v[52:53], 0
    v_mov_b64 v[54:55], 0
    v_mov_b64 v[56:57], 0
    v_mov_b64 v[58:59], 0
    v_mov_b64 v[60:61], 0
    v_mov_b64 v[62:63], 0
    v_mov_b64 v[64:65], 0
    v_mov_b64 v[66:67], 0
    v_mov_b64 v[68:69], 0
    v_mov_b64 v[70:71], 0
    v_mov_b64 v[72:73], 0
    v_mov_b64 v[74:75], 0
    v_mov_b64 v[76:77], 0
    v_mov_b64 v[78:79], 0
    v_mov_b64 v[80:81], 0
    v_mov_b64 v[82:83], 0
    v_mov_b64 v[84:85], 0
    v_mov_b64 v[86:87], 0
    v_mov_b64 v[88:89], 0
    v_mov_b64 v[90:91], 0
    v_mov_b64 v[92:93], 0
    v_mov_b64 v[94:95], 0
    v_mov_b64 v[96:97], 0
    v_mov_b64 v[98:99], 0
    v_mov_b64 v[100:101], 0
    v_mov_b64 v[102:103], 0
    v_mov_b64 v[104:105], 0
    v_mov_b64 v[106:107], 0
    v_mov_b64 v[108:109], 0
    v_mov_b64 v[110:111], 0
    v_mov_b64 v[112:113], 0
    v_mov_b64 v[114:115], 0
    v_mov_b64 v[116:117], 0
    v_mov_b64 v[118:119], 0
    v_mov_b64 v[120:121], 0
    v_mov_b64 v[122:123], 0
    v_mov_b64 v[124:125], 0
    v_mov_b64 v[126:127], 0
    v_mov_b64 v[128:129], 0
    v_mov_b64 v[130:131], 0
    v_mov_b64 v[132:133], 0
    v_mov_b64 v[134:135], 0
    v_mov_b64 v[136:137], 0
    v_mov_b64 v[138:139], 0
    v_mov_b64 v[140:141], 0
    v_mov_b64 v[142:143], 0
    v_mov_b64 v[144:145], 0
    v_mov_b64 v[146:147], 0
    v_mov_b64 v[148:149], 0
    v_mov_b64 v[150:151], 0
    v_mov_b64 v[152:153], 0
    v_mov_b64 v[154:155], 0
    s_waitcnt vmcnt(2)
    v_lshlrev_b32 v200, 16, v192
    v_and_b32 v201, 0xffff0000, v192
    v_lshlrev_b32 v208, 16, v196
    v_and_b32 v209, 0xffff0000, v196
    v_lshlrev_b32 v202, 16, v193
    v_and_b32 v203, 0xffff0000, v193
    v_lshlrev_b32 v210, 16, v197
    v_and_b32 v211, 0xffff0000, v197
    v_lshlrev_b32 v204, 16, v194
    v_and_b32 v205, 0xffff0000, v194
    v_lshlrev_b32 v212, 16, v198
    v_and_b32 v213, 0xffff0000, v198
    v_lshlrev_b32 v206, 16, v195
    v_and_b32 v207, 0xffff0000, v195
    v_lshlrev_b32 v214, 16, v199
    v_and_b32 v215, 0xffff0000, v199
    v_cvt_f32_i32 v160, v160
    v_cvt_f32_i32 v161, v161
    v_cvt_f32_i32 v162, v162
    v_cvt_f32_i32 v163, v163
    v_cvt_f32_i32 v164, v164
    v_cvt_f32_i32 v165, v165
    v_cvt_f32_i32 v166, v166
    v_cvt_f32_i32 v167, v167
    v_cvt_pk_bf16_f32 v160, 0, v160
    v_cvt_pk_bf16_f32 v161, 0, v161
    v_cvt_pk_bf16_f32 v162, 0, v162
    v_cvt_pk_bf16_f32 v163, 0, v163
    v_cvt_pk_bf16_f32 v164, 0, v164
    v_cvt_pk_bf16_f32 v165, 0, v165
    v_cvt_pk_bf16_f32 v166, 0, v166
    v_cvt_pk_bf16_f32 v167, 0, v167
    v_sub_f32 v160, v160, v208
    v_sub_f32 v161, v161, v209
    v_sub_f32 v162, v162, v210
    v_sub_f32 v163, v163, v211
    v_sub_f32 v164, v164, v212
    v_sub_f32 v165, v165, v213
    v_sub_f32 v166, v166, v214
    v_sub_f32 v167, v167, v215
    v_cvt_pk_bf16_f32 v160, 0, v160
    v_cvt_pk_bf16_f32 v161, 0, v161
    v_cvt_pk_bf16_f32 v162, 0, v162
    v_cvt_pk_bf16_f32 v163, 0, v163
    v_cvt_pk_bf16_f32 v164, 0, v164
    v_cvt_pk_bf16_f32 v165, 0, v165
    v_cvt_pk_bf16_f32 v166, 0, v166
    v_cvt_pk_bf16_f32 v167, 0, v167
    v_mul_f32 v160, v160, v200
    v_mul_f32 v161, v161, v201
    v_mul_f32 v162, v162, v202
    v_mul_f32 v163, v163, v203
    v_mul_f32 v164, v164, v204
    v_mul_f32 v165, v165, v205
    v_mul_f32 v166, v166, v206
    v_mul_f32 v167, v167, v207
    v_cvt_pk_bf16_f32 v160, v160, v161
    v_cvt_pk_bf16_f32 v161, v162, v163
    v_cvt_pk_bf16_f32 v162, v164, v165
    v_cvt_pk_bf16_f32 v163, v166, v167
    buffer_store_dwordx4 v[160:163], v1, s[12:15], s47 offen offset:0 sc1
    s_waitcnt vmcnt(1)
    v_cvt_f32_i32 v168, v168
    v_cvt_f32_i32 v169, v169
    v_cvt_f32_i32 v170, v170
    v_cvt_f32_i32 v171, v171
    v_cvt_f32_i32 v172, v172
    v_cvt_f32_i32 v173, v173
    v_cvt_f32_i32 v174, v174
    v_cvt_f32_i32 v175, v175
    v_cvt_pk_bf16_f32 v168, 0, v168
    v_cvt_pk_bf16_f32 v169, 0, v169
    v_cvt_pk_bf16_f32 v170, 0, v170
    v_cvt_pk_bf16_f32 v171, 0, v171
    v_cvt_pk_bf16_f32 v172, 0, v172
    v_cvt_pk_bf16_f32 v173, 0, v173
    v_cvt_pk_bf16_f32 v174, 0, v174
    v_cvt_pk_bf16_f32 v175, 0, v175
    v_sub_f32 v168, v168, v208
    v_sub_f32 v169, v169, v209
    v_sub_f32 v170, v170, v210
    v_sub_f32 v171, v171, v211
    v_sub_f32 v172, v172, v212
    v_sub_f32 v173, v173, v213
    v_sub_f32 v174, v174, v214
    v_sub_f32 v175, v175, v215
    v_cvt_pk_bf16_f32 v168, 0, v168
    v_cvt_pk_bf16_f32 v169, 0, v169
    v_cvt_pk_bf16_f32 v170, 0, v170
    v_cvt_pk_bf16_f32 v171, 0, v171
    v_cvt_pk_bf16_f32 v172, 0, v172
    v_cvt_pk_bf16_f32 v173, 0, v173
    v_cvt_pk_bf16_f32 v174, 0, v174
    v_cvt_pk_bf16_f32 v175, 0, v175
    v_mul_f32 v168, v168, v200
    v_mul_f32 v169, v169, v201
    v_mul_f32 v170, v170, v202
    v_mul_f32 v171, v171, v203
    v_mul_f32 v172, v172, v204
    v_mul_f32 v173, v173, v205
    v_mul_f32 v174, v174, v206
    v_mul_f32 v175, v175, v207
    v_cvt_pk_bf16_f32 v168, v168, v169
    v_cvt_pk_bf16_f32 v169, v170, v171
    v_cvt_pk_bf16_f32 v170, v172, v173
    v_cvt_pk_bf16_f32 v171, v174, v175
    buffer_store_dwordx4 v[168:171], v1, s[12:15], s47 offen offset:128 sc1
    s_add_u32 s16, s56, 8388608
    s_addc_u32 s17, s57, 0
    s_mov_b32 s18, 7340032
    s_mov_b32 s19, 0x20000
    s_add_u32 s8, s56, 33554432
    s_addc_u32 s9, s57, 0
    s_mov_b32 s10, 7340032
    s_mov_b32 s11, 0x20000
    v_lshrrev_b32 v3, 4, v2
    v_and_b32 v4, 15, v2
    s_lshl_b32 s44, s22, 8
    s_lshl_b32 s45, s25, 6
    s_add_u32 s44, s44, s45
    s_mul_i32 s44, s44, 7168
    s_lshl_b32 s45, s23, 8
    s_add_u32 s44, s44, s45
    s_add_u32 s45, s44, 114688
    s_add_u32 s46, s44, 229376
    s_add_u32 s47, s44, 344064
    v_and_b32 v5, 7, v4
    v_mul_u32_u24 v5, 7168, v5
    v_lshlrev_b32 v6, 4, v3
    v_and_b32 v7, 8, v4
    v_lshlrev_b32 v7, 3, v7
    v_add3_u32 v14, v5, v6, v7
    v_add_u32 v15, 57344, v14
    v_lshlrev_b32 v5, 2, v3
    v_sub_u32 v5, v4, v5
    v_and_b32 v6, 1, v5
    v_lshlrev_b32 v6, 4, v6
    v_mov_b32 v7, 0x3f80
    v_lshlrev_b32 v6, v6, v7
    v_lshrrev_b32 v5, 1, v5
    v_mov_b32 v7, 0
    v_cmp_eq_u32 vcc, 0, v5
    s_nop 1
    v_cndmask_b32 v24, v7, v6, vcc
    v_cmp_eq_u32 vcc, 1, v5
    s_nop 1
    v_cndmask_b32 v25, v7, v6, vcc
    v_lshlrev_b32 v13, 4, v2
    s_lshl_b32 s52, s23, 3
    s_add_u32 s52, s52, s22
    s_lshl_b32 s52, s52, 15
    s_lshl_b32 s26, s25, 13
    s_add_u32 s52, s52, s26
    s_add_u32 s53, s52, 4096
    s_xor_b32 s54, s52, 0x8000
    s_xor_b32 s55, s53, 0x8000
    s_waitcnt vmcnt(0) lgkmcnt(0)
    s_barrier
    v_mov_b64 v[22:23], 0
    v_mov_b64 v[26:27], 0
    s_and_b32 s26, s20, 1
    s_cselect_b32 s58, 23, 25
    v_add_u32 v8, s33, v16
    v_add_u32 v9, s33, v17
    v_add_u32 v10, s33, v18
    v_add_u32 v11, s33, v19
    v_add_u32 v12, s33, v20
    s_barrier
    ds_read_b128 v[156:159], v12 offset:0
    ds_read_b64_tr_b16 v[172:173], v8 offset:0
    ds_read_b64_tr_b16 v[174:175], v8 offset:8192
    ds_read_b128 v[160:163], v12 offset:1024
    ds_read_b64_tr_b16 v[176:177], v9 offset:0
    ds_read_b64_tr_b16 v[178:179], v9 offset:8192
    ds_read_b128 v[164:167], v12 offset:2048
    ds_read_b64_tr_b16 v[180:181], v10 offset:0
    ds_read_b64_tr_b16 v[182:183], v10 offset:8192
    ds_read_b128 v[168:171], v12 offset:3072
    ds_read_b64_tr_b16 v[184:185], v11 offset:0
    ds_read_b64_tr_b16 v[186:187], v11 offset:8192
    ds_read_b128 v[188:191], v12 offset:16384
    ds_read_b128 v[192:195], v12 offset:17408
    ds_read_b128 v[196:199], v12 offset:18432
    ds_read_b128 v[200:203], v12 offset:19456
    s_mov_b32 s36, s58
    s_branch L_gl_mid
L_gl_top:
    v_mfma_f32_16x16x32_bf16 v[92:95], v[204:207], v[220:223], v[92:95]
    v_mfma_f32_16x16x32_bf16 v[96:99], v[204:207], v[224:227], v[96:99]
    s_barrier
    ds_read_b128 v[156:159], v12 offset:0
    v_mfma_f32_16x16x32_bf16 v[100:103], v[204:207], v[228:231], v[100:103]
    ds_read_b64_tr_b16 v[172:173], v8 offset:0
    v_mfma_f32_16x16x32_bf16 v[104:107], v[204:207], v[232:235], v[104:107]
    ds_read_b64_tr_b16 v[174:175], v8 offset:8192
    v_mfma_f32_16x16x32_bf16 v[120:123], v[208:211], v[232:235], v[120:123]
    ds_read_b128 v[160:163], v12 offset:1024
    v_mfma_f32_16x16x32_bf16 v[116:119], v[208:211], v[228:231], v[116:119]
    ds_read_b64_tr_b16 v[176:177], v9 offset:0
    v_mfma_f32_16x16x32_bf16 v[112:115], v[208:211], v[224:227], v[112:115]
    ds_read_b64_tr_b16 v[178:179], v9 offset:8192
    v_mfma_f32_16x16x32_bf16 v[108:111], v[208:211], v[220:223], v[108:111]
    ds_read_b128 v[164:167], v12 offset:2048
    v_mfma_f32_16x16x32_bf16 v[124:127], v[212:215], v[220:223], v[124:127]
    ds_read_b64_tr_b16 v[180:181], v10 offset:0
    v_mfma_f32_16x16x32_bf16 v[128:131], v[212:215], v[224:227], v[128:131]
    ds_read_b64_tr_b16 v[182:183], v10 offset:8192
    v_mfma_f32_16x16x32_bf16 v[132:135], v[212:215], v[228:231], v[132:135]
    ds_read_b128 v[168:171], v12 offset:3072
    v_mfma_f32_16x16x32_bf16 v[136:139], v[212:215], v[232:235], v[136:139]
    ds_read_b64_tr_b16 v[184:185], v11 offset:0
    v_mfma_f32_16x16x32_bf16 v[152:155], v[216:219], v[232:235], v[152:155]
    ds_read_b64_tr_b16 v[186:187], v11 offset:8192
    v_mfma_f32_16x16x32_bf16 v[148:151], v[216:219], v[228:231], v[148:151]
    ds_read_b128 v[188:191], v12 offset:16384
    v_mfma_f32_16x16x32_bf16 v[144:147], v[216:219], v[224:227], v[144:147]
    ds_read_b128 v[192:195], v12 offset:17408
    v_mfma_f32_16x16x32_bf16 v[140:143], v[216:219], v[220:223], v[140:143]
    ds_read_b128 v[196:199], v12 offset:18432
    v_mfma_f32_16x16x32_bf16 v[28:31], v[236:239], v[220:223], v[28:31]
    ds_read_b128 v[200:203], v12 offset:19456
    v_mfma_f32_16x16x32_bf16 v[32:35], v[236:239], v[224:227], v[32:35]
    v_mfma_f32_16x16x32_bf16 v[36:39], v[236:239], v[228:231], v[36:39]
    v_mfma_f32_16x16x32_bf16 v[40:43], v[236:239], v[232:235], v[40:43]
    v_mfma_f32_16x16x32_bf16 v[56:59], v[240:243], v[232:235], v[56:59]
    v_mfma_f32_16x16x32_bf16 v[52:55], v[240:243], v[228:231], v[52:55]
    v_mfma_f32_16x16x32_bf16 v[48:51], v[240:243], v[224:227], v[48:51]
    v_mfma_f32_16x16x32_bf16 v[44:47], v[240:243], v[220:223], v[44:47]
    v_mfma_f32_16x16x32_bf16 v[60:63], v[244:247], v[220:223], v[60:63]
    v_mfma_f32_16x16x32_bf16 v[64:67], v[244:247], v[224:227], v[64:67]
    v_mfma_f32_16x16x32_bf16 v[68:71], v[244:247], v[228:231], v[68:71]
    v_mfma_f32_16x16x32_bf16 v[72:75], v[244:247], v[232:235], v[72:75]
    v_mfma_f32_16x16x32_bf16 v[88:91], v[248:251], v[232:235], v[88:91]
    v_mfma_f32_16x16x32_bf16 v[84:87], v[248:251], v[228:231], v[84:87]
    v_mfma_f32_16x16x32_bf16 v[80:83], v[248:251], v[224:227], v[80:83]
    v_mfma_f32_16x16x32_bf16 v[76:79], v[248:251], v[220:223], v[76:79]
L_gl_mid:
    s_waitcnt lgkmcnt(0)
    v_mfma_f32_16x16x32_bf16 v[92:95], v[156:159], v[172:175], v[92:95]
    ds_read_b128 v[204:207], v12 offset:8192
    s_add_u32 s33, s33, 49152
    v_mfma_f32_16x16x32_bf16 v[96:99], v[156:159], v[176:179], v[96:99]
    ds_read_b64_tr_b16 v[220:221], v8 offset:4096
    s_cmp_eq_u32 s33, 147456
    v_mfma_f32_16x16x32_bf16 v[100:103], v[156:159], v[180:183], v[100:103]
    ds_read_b64_tr_b16 v[222:223], v8 offset:12288
    s_cselect_b32 s33, 0, s33
    v_mfma_f32_16x16x32_bf16 v[104:107], v[156:159], v[184:187], v[104:107]
    ds_read_b128 v[208:211], v12 offset:9216
    v_add_u32 v8, s33, v16
    s_sub_u32 s36, s36, 1
    v_mfma_f32_16x16x32_bf16 v[120:123], v[160:163], v[184:187], v[120:123]
    ds_read_b64_tr_b16 v[224:225], v9 offset:4096
    s_cmp_lg_u32 s36, 0
    v_mfma_f32_16x16x32_bf16 v[116:119], v[160:163], v[180:183], v[116:119]
    ds_read_b64_tr_b16 v[226:227], v9 offset:12288
    v_add_u32 v9, s33, v17
    v_mfma_f32_16x16x32_bf16 v[112:115], v[160:163], v[176:179], v[112:115]
    ds_read_b128 v[212:215], v12 offset:10240
    v_mfma_f32_16x16x32_bf16 v[108:111], v[160:163], v[172:175], v[108:111]
    ds_read_b64_tr_b16 v[228:229], v10 offset:4096
    v_mfma_f32_16x16x32_bf16 v[124:127], v[164:167], v[172:175], v[124:127]
    ds_read_b64_tr_b16 v[230:231], v10 offset:12288
    v_add_u32 v10, s33, v18
    v_mfma_f32_16x16x32_bf16 v[128:131], v[164:167], v[176:179], v[128:131]
    ds_read_b128 v[216:219], v12 offset:11264
    v_mfma_f32_16x16x32_bf16 v[132:135], v[164:167], v[180:183], v[132:135]
    ds_read_b64_tr_b16 v[232:233], v11 offset:4096
    v_mfma_f32_16x16x32_bf16 v[136:139], v[164:167], v[184:187], v[136:139]
    ds_read_b64_tr_b16 v[234:235], v11 offset:12288
    v_add_u32 v11, s33, v19
    v_mfma_f32_16x16x32_bf16 v[152:155], v[168:171], v[184:187], v[152:155]
    ds_read_b128 v[236:239], v12 offset:24576
    v_mfma_f32_16x16x32_bf16 v[148:151], v[168:171], v[180:183], v[148:151]
    ds_read_b128 v[240:243], v12 offset:25600
    v_mfma_f32_16x16x32_bf16 v[144:147], v[168:171], v[176:179], v[144:147]
    ds_read_b128 v[244:247], v12 offset:26624
    v_mfma_f32_16x16x32_bf16 v[140:143], v[168:171], v[172:175], v[140:143]
    ds_read_b128 v[248:251], v12 offset:27648
    v_add_u32 v12, s33, v20
    v_mfma_f32_16x16x32_bf16 v[28:31], v[188:191], v[172:175], v[28:31]
    v_mfma_f32_16x16x32_bf16 v[32:35], v[188:191], v[176:179], v[32:35]
    v_mfma_f32_16x16x32_bf16 v[36:39], v[188:191], v[180:183], v[36:39]
    v_mfma_f32_16x16x32_bf16 v[40:43], v[188:191], v[184:187], v[40:43]
    v_mfma_f32_16x16x32_bf16 v[56:59], v[192:195], v[184:187], v[56:59]
    v_mfma_f32_16x16x32_bf16 v[52:55], v[192:195], v[180:183], v[52:55]
    v_mfma_f32_16x16x32_bf16 v[48:51], v[192:195], v[176:179], v[48:51]
    v_mfma_f32_16x16x32_bf16 v[44:47], v[192:195], v[172:175], v[44:47]
    v_mfma_f32_16x16x32_bf16 v[60:63], v[196:199], v[172:175], v[60:63]
    v_mfma_f32_16x16x32_bf16 v[64:67], v[196:199], v[176:179], v[64:67]
    v_mfma_f32_16x16x32_bf16 v[68:71], v[196:199], v[180:183], v[68:71]
    v_mfma_f32_16x16x32_bf16 v[72:75], v[196:199], v[184:187], v[72:75]
    v_mfma_f32_16x16x32_bf16 v[88:91], v[200:203], v[184:187], v[88:91]
    v_mfma_f32_16x16x32_bf16 v[84:87], v[200:203], v[180:183], v[84:87]
    v_mfma_f32_16x16x32_bf16 v[80:83], v[200:203], v[176:179], v[80:83]
    v_mfma_f32_16x16x32_bf16 v[76:79], v[200:203], v[172:175], v[76:79]
    s_waitcnt lgkmcnt(0)
    s_cbranch_scc1 L_gl_top
    v_mfma_f32_16x16x32_bf16 v[92:95], v[204:207], v[220:223], v[92:95]
    v_mfma_f32_16x16x32_bf16 v[96:99], v[204:207], v[224:227], v[96:99]
    s_barrier
    ds_read_b128 v[156:159], v12 offset:0
    v_mfma_f32_16x16x32_bf16 v[100:103], v[204:207], v[228:231], v[100:103]
    ds_read_b64_tr_b16 v[172:173], v8 offset:0
    v_mfma_f32_16x16x32_bf16 v[104:107], v[204:207], v[232:235], v[104:107]
    ds_read_b64_tr_b16 v[174:175], v8 offset:8192
    v_mfma_f32_16x16x32_bf16 v[120:123], v[208:211], v[232:235], v[120:123]
    ds_read_b128 v[160:163], v12 offset:1024
    v_mfma_f32_16x16x32_bf16 v[116:119], v[208:211], v[228:231], v[116:119]
    ds_read_b64_tr_b16 v[176:177], v9 offset:0
    v_mfma_f32_16x16x32_bf16 v[112:115], v[208:211], v[224:227], v[112:115]
    ds_read_b64_tr_b16 v[178:179], v9 offset:8192
    v_mfma_f32_16x16x32_bf16 v[108:111], v[208:211], v[220:223], v[108:111]
    ds_read_b128 v[164:167], v12 offset:2048
    v_mfma_f32_16x16x32_bf16 v[124:127], v[212:215], v[220:223], v[124:127]
    ds_read_b64_tr_b16 v[180:181], v10 offset:0
    v_mfma_f32_16x16x32_bf16 v[128:131], v[212:215], v[224:227], v[128:131]
    ds_read_b64_tr_b16 v[182:183], v10 offset:8192
    v_mfma_f32_16x16x32_bf16 v[132:135], v[212:215], v[228:231], v[132:135]
    ds_read_b128 v[168:171], v12 offset:3072
    v_mfma_f32_16x16x32_bf16 v[136:139], v[212:215], v[232:235], v[136:139]
    ds_read_b64_tr_b16 v[184:185], v11 offset:0
    v_mfma_f32_16x16x32_bf16 v[152:155], v[216:219], v[232:235], v[152:155]
    ds_read_b64_tr_b16 v[186:187], v11 offset:8192
    v_mfma_f32_16x16x32_bf16 v[148:151], v[216:219], v[228:231], v[148:151]
    v_mfma_f32_16x16x32_bf16 v[144:147], v[216:219], v[224:227], v[144:147]
    v_cvt_pk_bf16_f32 v92, v92, v93
    v_cvt_pk_bf16_f32 v93, v94, v95
    v_cvt_pk_bf16_f32 v94, v108, v109
    v_mfma_f32_16x16x32_bf16 v[140:143], v[216:219], v[220:223], v[140:143]
    v_cvt_pk_bf16_f32 v95, v110, v111
    buffer_store_dwordx4 v[92:95], v13, s[8:11], s54 offen offset:0 sc1
    v_cvt_pk_bf16_f32 v96, v96, v97
    v_mfma_f32_16x16x32_bf16 v[28:31], v[236:239], v[220:223], v[28:31]
    v_cvt_pk_bf16_f32 v97, v98, v99
    v_cvt_pk_bf16_f32 v98, v112, v113
    v_cvt_pk_bf16_f32 v99, v114, v115
    v_mfma_f32_16x16x32_bf16 v[32:35], v[236:239], v[224:227], v[32:35]
    buffer_store_dwordx4 v[96:99], v13, s[8:11], s54 offen offset:1024 sc1
    v_cvt_pk_bf16_f32 v100, v100, v101
    v_cvt_pk_bf16_f32 v101, v102, v103
    v_mfma_f32_16x16x32_bf16 v[36:39], v[236:239], v[228:231], v[36:39]
    v_cvt_pk_bf16_f32 v102, v116, v117
    v_cvt_pk_bf16_f32 v103, v118, v119
    buffer_store_dwordx4 v[100:103], v13, s[8:11], s54 offen offset:2048 sc1
    v_mfma_f32_16x16x32_bf16 v[40:43], v[236:239], v[232:235], v[40:43]
    v_cvt_pk_bf16_f32 v104, v104, v105
    v_cvt_pk_bf16_f32 v105, v106, v107
    v_cvt_pk_bf16_f32 v106, v120, v121
    v_mfma_f32_16x16x32_bf16 v[56:59], v[240:243], v[232:235], v[56:59]
    v_cvt_pk_bf16_f32 v107, v122, v123
    buffer_store_dwordx4 v[104:107], v13, s[8:11], s54 offen offset:3072 sc1
    v_cvt_pk_bf16_f32 v124, v124, v125
    v_mfma_f32_16x16x32_bf16 v[52:55], v[240:243], v[228:231], v[52:55]
    v_cvt_pk_bf16_f32 v125, v126, v127
    v_cvt_pk_bf16_f32 v126, v140, v141
    v_cvt_pk_bf16_f32 v127, v142, v143
    v_mfma_f32_16x16x32_bf16 v[48:51], v[240:243], v[224:227], v[48:51]
    buffer_store_dwordx4 v[124:127], v13, s[8:11], s55 offen offset:0 sc1
    v_cvt_pk_bf16_f32 v128, v128, v129
    v_cvt_pk_bf16_f32 v129, v130, v131
    v_mfma_f32_16x16x32_bf16 v[44:47], v[240:243], v[220:223], v[44:47]
    v_cvt_pk_bf16_f32 v130, v144, v145
    v_cvt_pk_bf16_f32 v131, v146, v147
    buffer_store_dwordx4 v[128:131], v13, s[8:11], s55 offen offset:1024 sc1
    v_mfma_f32_16x16x32_bf16 v[60:63], v[244:247], v[220:223], v[60:63]
    v_cvt_pk_bf16_f32 v132, v132, v133
    v_cvt_pk_bf16_f32 v133, v134, v135
    v_cvt_pk_bf16_f32 v134, v148, v149
    v_mfma_f32_16x16x32_bf16 v[64:67], v[244:247], v[224:227], v[64:67]
    v_cvt_pk_bf16_f32 v135, v150, v151
    buffer_store_dwordx4 v[132:135], v13, s[8:11], s55 offen offset:2048 sc1
    v_cvt_pk_bf16_f32 v136, v136, v137
    v_mfma_f32_16x16x32_bf16 v[68:71], v[244:247], v[228:231], v[68:71]
    v_cvt_pk_bf16_f32 v137, v138, v139
    v_cvt_pk_bf16_f32 v138, v152, v153
    v_cvt_pk_bf16_f32 v139, v154, v155
    v_mfma_f32_16x16x32_bf16 v[72:75], v[244:247], v[232:235], v[72:75]
    buffer_store_dwordx4 v[136:139], v13, s[8:11], s55 offen offset:3072 sc1
    v_mfma_f32_16x16x32_bf16 v[88:91], v[248:251], v[232:235], v[88:91]
    v_mfma_f32_16x16x32_bf16 v[84:87], v[248:251], v[228:231], v[84:87]
    v_mfma_f32_16x16x32_bf16 v[80:83], v[248:251], v[224:227], v[80:83]
    v_mfma_f32_16x16x32_bf16 v[76:79], v[248:251], v[220:223], v[76:79]
    s_waitcnt lgkmcnt(0)
    s_add_u32 s33, s33, 49152
    s_cmp_eq_u32 s33, 147456
    s_cselect_b32 s33, 0, s33
    v_mfma_f32_16x16x32_bf16 v[28:31], v[156:159], v[172:175], v[28:31]
    ds_read_b128 v[204:207], v12 offset:8192
    v_mfma_f32_16x16x32_bf16 v[32:35], v[156:159], v[176:179], v[32:35]
    ds_read_b64_tr_b16 v[220:221], v8 offset:4096
    v_mfma_f32_16x16x32_bf16 v[36:39], v[156:159], v[180:183], v[36:39]
    ds_read_b64_tr_b16 v[222:223], v8 offset:12288
    v_mov_b64 v[108:109], 0
    v_mov_b64 v[110:111], 0
    v_mfma_f32_16x16x32_bf16 v[40:43], v[156:159], v[184:187], v[40:43]
    ds_read_b128 v[208:211], v12 offset:9216
    v_mov_b64 v[112:113], 0
    v_mov_b64 v[114:115], 0
    v_mfma_f32_16x16x32_bf16 v[56:59], v[160:163], v[184:187], v[56:59]
    ds_read_b64_tr_b16 v[224:225], v9 offset:4096
    v_mov_b64 v[116:117], 0
    v_mov_b64 v[118:119], 0
    v_mfma_f32_16x16x32_bf16 v[52:55], v[160:163], v[180:183], v[52:55]
    ds_read_b64_tr_b16 v[226:227], v9 offset:12288
    v_mov_b64 v[120:121], 0
    v_mov_b64 v[122:123], 0
    v_mfma_f32_16x16x32_bf16 v[48:51], v[160:163], v[176:179], v[48:51]
    ds_read_b128 v[212:215], v12 offset:10240
    v_mov_b64 v[140:141], 0
    v_mov_b64 v[142:143], 0
    v_mfma_f32_16x16x32_bf16 v[44:47], v[160:163], v[172:175], v[44:47]
    ds_read_b64_tr_b16 v[228:229], v10 offset:4096
    v_mov_b64 v[144:145], 0
    v_mov_b64 v[146:147], 0
    v_mfma_f32_16x16x32_bf16 v[60:63], v[164:167], v[172:175], v[60:63]
    ds_read_b64_tr_b16 v[230:231], v10 offset:12288
    v_mov_b64 v[148:149], 0
    v_mov_b64 v[150:151], 0
    v_mfma_f32_16x16x32_bf16 v[64:67], v[164:167], v[176:179], v[64:67]
    ds_read_b128 v[216:219], v12 offset:11264
    v_mov_b64 v[152:153], 0
    v_mov_b64 v[154:155], 0
    v_mfma_f32_16x16x32_bf16 v[68:71], v[164:167], v[180:183], v[68:71]
    ds_read_b64_tr_b16 v[232:233], v11 offset:4096
    v_mov_b64 v[92:93], 0
    v_mov_b64 v[94:95], 0
    v_mfma_f32_16x16x32_bf16 v[72:75], v[164:167], v[184:187], v[72:75]
    ds_read_b64_tr_b16 v[234:235], v11 offset:12288
    v_mov_b64 v[96:97], 0
    v_mov_b64 v[98:99], 0
    v_mfma_f32_16x16x32_bf16 v[88:91], v[168:171], v[184:187], v[88:91]
    v_mov_b64 v[100:101], 0
    v_mov_b64 v[102:103], 0
    v_mov_b64 v[104:105], 0
    v_mfma_f32_16x16x32_bf16 v[84:87], v[168:171], v[180:183], v[84:87]
    v_mov_b64 v[106:107], 0
    v_mov_b64 v[124:125], 0
    v_mov_b64 v[126:127], 0
    v_mfma_f32_16x16x32_bf16 v[80:83], v[168:171], v[176:179], v[80:83]
    v_mov_b64 v[128:129], 0
    v_mov_b64 v[130:131], 0
    v_mov_b64 v[132:133], 0
    v_mfma_f32_16x16x32_bf16 v[76:79], v[168:171], v[172:175], v[76:79]
    v_mov_b64 v[134:135], 0
    v_mov_b64 v[136:137], 0
    v_mov_b64 v[138:139], 0
    v_add_u32 v8, s33, v16
    v_add_u32 v9, s33, v17
    v_add_u32 v10, s33, v18
    v_add_u32 v11, s33, v19
    v_add_u32 v12, s33, v20
    s_waitcnt lgkmcnt(0)
    v_mfma_f32_16x16x32_bf16 v[28:31], v[204:207], v[220:223], v[28:31]
    v_mfma_f32_16x16x32_bf16 v[32:35], v[204:207], v[224:227], v[32:35]
    s_barrier
    ds_read_b128 v[156:159], v12 offset:0
    v_mfma_f32_16x16x32_bf16 v[36:39], v[204:207], v[228:231], v[36:39]
    ds_read_b64_tr_b16 v[172:173], v8 offset:0
    v_mfma_f32_16x16x32_bf16 v[40:43], v[204:207], v[232:235], v[40:43]
    ds_read_b64_tr_b16 v[174:175], v8 offset:8192
    v_mfma_f32_16x16x32_bf16 v[56:59], v[208:211], v[232:235], v[56:59]
    ds_read_b128 v[160:163], v12 offset:1024
    v_mfma_f32_16x16x32_bf16 v[52:55], v[208:211], v[228:231], v[52:55]
    ds_read_b64_tr_b16 v[176:177], v9 offset:0
    v_mfma_f32_16x16x32_bf16 v[48:51], v[208:211], v[224:227], v[48:51]
    ds_read_b64_tr_b16 v[178:179], v9 offset:8192
    v_mfma_f32_16x16x32_bf16 v[44:47], v[208:211], v[220:223], v[44:47]
    ds_read_b128 v[164:167], v12 offset:2048
    v_mfma_f32_16x16x32_bf16 v[60:63], v[212:215], v[220:223], v[60:63]
    ds_read_b64_tr_b16 v[180:181], v10 offset:0
    v_mfma_f32_16x16x32_bf16 v[64:67], v[212:215], v[224:227], v[64:67]
    ds_read_b64_tr_b16 v[182:183], v10 offset:8192
    v_mfma_f32_16x16x32_bf16 v[68:71], v[212:215], v[228:231], v[68:71]
    ds_read_b128 v[168:171], v12 offset:3072
    v_mfma_f32_16x16x32_bf16 v[72:75], v[212:215], v[232:235], v[72:75]
    ds_read_b64_tr_b16 v[184:185], v11 offset:0
    v_mfma_f32_16x16x32_bf16 v[88:91], v[216:219], v[232:235], v[88:91]
    ds_read_b64_tr_b16 v[186:187], v11 offset:8192
    v_mfma_f32_16x16x32_bf16 v[84:87], v[216:219], v[228:231], v[84:87]
    v_mfma_f32_16x16x32_bf16 v[80:83], v[216:219], v[224:227], v[80:83]
    v_mfma_f32_16x16x32_bf16 v[76:79], v[216:219], v[220:223], v[76:79]
    s_waitcnt lgkmcnt(0)
    s_add_u32 s33, s33, 49152
    s_cmp_eq_u32 s33, 147456
    s_cselect_b32 s33, 0, s33
    v_mfma_f32_16x16x32_bf16 v[28:31], v[156:159], v[172:175], v[28:31]
    ds_read_b128 v[204:207], v12 offset:8192
    v_mfma_f32_16x16x32_bf16 v[32:35], v[156:159], v[176:179], v[32:35]
    ds_read_b64_tr_b16 v[220:221], v8 offset:4096
    v_mfma_f32_16x16x32_bf16 v[36:39], v[156:159], v[180:183], v[36:39]
    ds_read_b64_tr_b16 v[222:223], v8 offset:12288
    v_mfma_f32_16x16x32_bf16 v[40:43], v[156:159], v[184:187], v[40:43]
    ds_read_b128 v[208:211], v12 offset:9216
    v_mfma_f32_16x16x32_bf16 v[56:59], v[160:163], v[184:187], v[56:59]
    ds_read_b64_tr_b16 v[224:225], v9 offset:4096
    v_mfma_f32_16x16x32_bf16 v[52:55], v[160:163], v[180:183], v[52:55]
    ds_read_b64_tr_b16 v[226:227], v9 offset:12288
    v_mfma_f32_16x16x32_bf16 v[48:51], v[160:163], v[176:179], v[48:51]
    ds_read_b128 v[212:215], v12 offset:10240
    v_mfma_f32_16x16x32_bf16 v[44:47], v[160:163], v[172:175], v[44:47]
    ds_read_b64_tr_b16 v[228:229], v10 offset:4096
    v_mfma_f32_16x16x32_bf16 v[60:63], v[164:167], v[172:175], v[60:63]
    ds_read_b64_tr_b16 v[230:231], v10 offset:12288
    v_mfma_f32_16x16x32_bf16 v[64:67], v[164:167], v[176:179], v[64:67]
    ds_read_b128 v[216:219], v12 offset:11264
    v_mfma_f32_16x16x32_bf16 v[68:71], v[164:167], v[180:183], v[68:71]
    ds_read_b64_tr_b16 v[232:233], v11 offset:4096
    v_mfma_f32_16x16x32_bf16 v[72:75], v[164:167], v[184:187], v[72:75]
    ds_read_b64_tr_b16 v[234:235], v11 offset:12288
    v_mfma_f32_16x16x32_bf16 v[88:91], v[168:171], v[184:187], v[88:91]
    v_mfma_f32_16x16x32_bf16 v[84:87], v[168:171], v[180:183], v[84:87]
    v_mfma_f32_16x16x32_bf16 v[80:83], v[168:171], v[176:179], v[80:83]
    v_mfma_f32_16x16x32_bf16 v[76:79], v[168:171], v[172:175], v[76:79]
    v_add_u32 v8, s33, v16
    v_add_u32 v9, s33, v17
    v_add_u32 v10, s33, v18
    v_add_u32 v11, s33, v19
    v_add_u32 v12, s33, v20
    s_waitcnt vmcnt(0) lgkmcnt(0)
    v_mfma_f32_16x16x32_bf16 v[28:31], v[204:207], v[220:223], v[28:31]
    v_mfma_f32_16x16x32_bf16 v[32:35], v[204:207], v[224:227], v[32:35]
    s_barrier
    ds_read_b128 v[156:159], v12 offset:0
    v_mfma_f32_16x16x32_bf16 v[36:39], v[204:207], v[228:231], v[36:39]
    ds_read_b64_tr_b16 v[172:173], v8 offset:0
    v_mfma_f32_16x16x32_bf16 v[40:43], v[204:207], v[232:235], v[40:43]
    ds_read_b64_tr_b16 v[174:175], v8 offset:8192
    v_mfma_f32_16x16x32_bf16 v[56:59], v[208:211], v[232:235], v[56:59]
    ds_read_b128 v[160:163], v12 offset:1024
    v_mfma_f32_16x16x32_bf16 v[52:55], v[208:211], v[228:231], v[52:55]
    ds_read_b64_tr_b16 v[176:177], v9 offset:0
    v_mfma_f32_16x16x32_bf16 v[48:51], v[208:211], v[224:227], v[48:51]
    ds_read_b64_tr_b16 v[178:179], v9 offset:8192
    v_mfma_f32_16x16x32_bf16 v[44:47], v[208:211], v[220:223], v[44:47]
    ds_read_b128 v[164:167], v12 offset:2048
    v_mfma_f32_16x16x32_bf16 v[60:63], v[212:215], v[220:223], v[60:63]
    ds_read_b64_tr_b16 v[180:181], v10 offset:0
    v_mfma_f32_16x16x32_bf16 v[64:67], v[212:215], v[224:227], v[64:67]
    ds_read_b64_tr_b16 v[182:183], v10 offset:8192
    v_mfma_f32_16x16x32_bf16 v[68:71], v[212:215], v[228:231], v[68:71]
    ds_read_b128 v[168:171], v12 offset:3072
    v_mfma_f32_16x16x32_bf16 v[72:75], v[212:215], v[232:235], v[72:75]
    ds_read_b64_tr_b16 v[184:185], v11 offset:0
    v_mfma_f32_16x16x32_bf16 v[88:91], v[216:219], v[232:235], v[88:91]
    ds_read_b64_tr_b16 v[186:187], v11 offset:8192
    v_mfma_f32_16x16x32_bf16 v[84:87], v[216:219], v[228:231], v[84:87]
    v_mfma_f32_16x16x32_bf16 v[80:83], v[216:219], v[224:227], v[80:83]
    v_mfma_f32_16x16x32_bf16 v[76:79], v[216:219], v[220:223], v[76:79]
    s_mov_b32 s36, 6
    s_branch L_gs_mid
L_gs_post:
    buffer_load_dwordx4 v[188:191], v13, s[8:11], s52 offen offset:0 sc1
    buffer_load_dwordx4 v[192:195], v13, s[8:11], s52 offen offset:1024 sc1
    buffer_load_dwordx4 v[196:199], v13, s[8:11], s52 offen offset:2048 sc1
    buffer_load_dwordx4 v[200:203], v13, s[8:11], s52 offen offset:3072 sc1
    buffer_load_dwordx4 v[236:239], v13, s[8:11], s53 offen offset:0 sc1
    buffer_load_dwordx4 v[240:243], v13, s[8:11], s53 offen offset:1024 sc1
    buffer_load_dwordx4 v[244:247], v13, s[8:11], s53 offen offset:2048 sc1
    buffer_load_dwordx4 v[248:251], v13, s[8:11], s53 offen offset:3072 sc1
    s_branch L_gs_postb
L_gs_top:
    v_mfma_f32_16x16x32_bf16 v[28:31], v[204:207], v[220:223], v[28:31]
    v_mfma_f32_16x16x32_bf16 v[32:35], v[204:207], v[224:227], v[32:35]
    s_cmp_eq_u32 s36, 2
    s_barrier
    s_cbranch_scc1 L_gs_post
L_gs_postb:
    ds_read_b128 v[156:159], v12 offset:0
    v_mfma_f32_16x16x32_bf16 v[36:39], v[204:207], v[228:231], v[36:39]
    ds_read_b64_tr_b16 v[172:173], v8 offset:0
    v_mfma_f32_16x16x32_bf16 v[40:43], v[204:207], v[232:235], v[40:43]
    ds_read_b64_tr_b16 v[174:175], v8 offset:8192
    v_mfma_f32_16x16x32_bf16 v[56:59], v[208:211], v[232:235], v[56:59]
    ds_read_b128 v[160:163], v12 offset:1024
    v_mfma_f32_16x16x32_bf16 v[52:55], v[208:211], v[228:231], v[52:55]
    ds_read_b64_tr_b16 v[176:177], v9 offset:0
    v_mfma_f32_16x16x32_bf16 v[48:51], v[208:211], v[224:227], v[48:51]
    ds_read_b64_tr_b16 v[178:179], v9 offset:8192
    v_mfma_f32_16x16x32_bf16 v[44:47], v[208:211], v[220:223], v[44:47]
    ds_read_b128 v[164:167], v12 offset:2048
    v_mfma_f32_16x16x32_bf16 v[60:63], v[212:215], v[220:223], v[60:63]
    ds_read_b64_tr_b16 v[180:181], v10 offset:0
    v_mfma_f32_16x16x32_bf16 v[64:67], v[212:215], v[224:227], v[64:67]
    ds_read_b64_tr_b16 v[182:183], v10 offset:8192
    v_mfma_f32_16x16x32_bf16 v[68:71], v[212:215], v[228:231], v[68:71]
    ds_read_b128 v[168:171], v12 offset:3072
    v_mfma_f32_16x16x32_bf16 v[72:75], v[212:215], v[232:235], v[72:75]
    ds_read_b64_tr_b16 v[184:185], v11 offset:0
    v_mfma_f32_16x16x32_bf16 v[88:91], v[216:219], v[232:235], v[88:91]
    ds_read_b64_tr_b16 v[186:187], v11 offset:8192
    v_mfma_f32_16x16x32_bf16 v[84:87], v[216:219], v[228:231], v[84:87]
    v_mfma_f32_16x16x32_bf16 v[80:83], v[216:219], v[224:227], v[80:83]
    v_mfma_f32_16x16x32_bf16 v[76:79], v[216:219], v[220:223], v[76:79]
L_gs_mid:
    s_waitcnt lgkmcnt(0)
    v_mfma_f32_16x16x32_bf16 v[28:31], v[156:159], v[172:175], v[28:31]
    ds_read_b128 v[204:207], v12 offset:8192
    s_add_u32 s33, s33, 49152
    v_mfma_f32_16x16x32_bf16 v[32:35], v[156:159], v[176:179], v[32:35]
    ds_read_b64_tr_b16 v[220:221], v8 offset:4096
    s_cmp_eq_u32 s33, 147456
    v_mfma_f32_16x16x32_bf16 v[36:39], v[156:159], v[180:183], v[36:39]
    ds_read_b64_tr_b16 v[222:223], v8 offset:12288
    s_cselect_b32 s33, 0, s33
    v_mfma_f32_16x16x32_bf16 v[40:43], v[156:159], v[184:187], v[40:43]
    ds_read_b128 v[208:211], v12 offset:9216
    v_add_u32 v8, s33, v16
    s_sub_u32 s36, s36, 1
    v_mfma_f32_16x16x32_bf16 v[56:59], v[160:163], v[184:187], v[56:59]
    ds_read_b64_tr_b16 v[224:225], v9 offset:4096
    s_cmp_lg_u32 s36, 0
    v_mfma_f32_16x16x32_bf16 v[52:55], v[160:163], v[180:183], v[52:55]
    ds_read_b64_tr_b16 v[226:227], v9 offset:12288
    v_add_u32 v9, s33, v17
    v_mfma_f32_16x16x32_bf16 v[48:51], v[160:163], v[176:179], v[48:51]
    ds_read_b128 v[212:215], v12 offset:10240
    v_mfma_f32_16x16x32_bf16 v[44:47], v[160:163], v[172:175], v[44:47]
    ds_read_b64_tr_b16 v[228:229], v10 offset:4096
    v_mfma_f32_16x16x32_bf16 v[60:63], v[164:167], v[172:175], v[60:63]
    ds_read_b64_tr_b16 v[230:231], v10 offset:12288
    v_add_u32 v10, s33, v18
    v_mfma_f32_16x16x32_bf16 v[64:67], v[164:167], v[176:179], v[64:67]
    ds_read_b128 v[216:219], v12 offset:11264
    v_mfma_f32_16x16x32_bf16 v[68:71], v[164:167], v[180:183], v[68:71]
    ds_read_b64_tr_b16 v[232:233], v11 offset:4096
    v_mfma_f32_16x16x32_bf16 v[72:75], v[164:167], v[184:187], v[72:75]
    ds_read_b64_tr_b16 v[234:235], v11 offset:12288
    v_add_u32 v11, s33, v19
    v_mfma_f32_16x16x32_bf16 v[88:91], v[168:171], v[184:187], v[88:91]
    v_add_u32 v12, s33, v20
    v_mfma_f32_16x16x32_bf16 v[84:87], v[168:171], v[180:183], v[84:87]
    v_mfma_f32_16x16x32_bf16 v[80:83], v[168:171], v[176:179], v[80:83]
    v_mfma_f32_16x16x32_bf16 v[76:79], v[168:171], v[172:175], v[76:79]
    s_waitcnt lgkmcnt(0)
    s_cbranch_scc1 L_gs_top
    v_mfma_f32_16x16x32_bf16 v[28:31], v[204:207], v[220:223], v[28:31]
    v_mfma_f32_16x16x32_bf16 v[32:35], v[204:207], v[224:227], v[32:35]
    v_mfma_f32_16x16x32_bf16 v[36:39], v[204:207], v[228:231], v[36:39]
    v_mfma_f32_16x16x32_bf16 v[40:43], v[204:207], v[232:235], v[40:43]
    v_mfma_f32_16x16x32_bf16 v[56:59], v[208:211], v[232:235], v[56:59]
    v_mfma_f32_16x16x32_bf16 v[52:55], v[208:211], v[228:231], v[52:55]
    v_mfma_f32_16x16x32_bf16 v[48:51], v[208:211], v[224:227], v[48:51]
    v_mfma_f32_16x16x32_bf16 v[44:47], v[208:211], v[220:223], v[44:47]
    v_mfma_f32_16x16x32_bf16 v[60:63], v[212:215], v[220:223], v[60:63]
    v_mfma_f32_16x16x32_bf16 v[64:67], v[212:215], v[224:227], v[64:67]
    v_mfma_f32_16x16x32_bf16 v[68:71], v[212:215], v[228:231], v[68:71]
    v_mfma_f32_16x16x32_bf16 v[72:75], v[212:215], v[232:235], v[72:75]
    v_mfma_f32_16x16x32_bf16 v[88:91], v[216:219], v[232:235], v[88:91]
    v_mfma_f32_16x16x32_bf16 v[84:87], v[216:219], v[228:231], v[84:87]
    v_mfma_f32_16x16x32_bf16 v[80:83], v[216:219], v[224:227], v[80:83]
    v_mfma_f32_16x16x32_bf16 v[76:79], v[216:219], v[220:223], v[76:79]
    s_waitcnt vmcnt(0)
    v_mfma_f32_16x16x32_bf16 v[28:31], v[24:27], v[188:191], v[28:31]
    v_mfma_f32_16x16x32_bf16 v[44:47], v[22:25], v[188:191], v[44:47]
    v_mfma_f32_16x16x32_bf16 v[60:63], v[24:27], v[236:239], v[60:63]
    v_mfma_f32_16x16x32_bf16 v[76:79], v[22:25], v[236:239], v[76:79]
    v_mfma_f32_16x16x32_bf16 v[32:35], v[24:27], v[192:195], v[32:35]
    v_mfma_f32_16x16x32_bf16 v[48:51], v[22:25], v[192:195], v[48:51]
    v_mfma_f32_16x16x32_bf16 v[64:67], v[24:27], v[240:243], v[64:67]
    v_mfma_f32_16x16x32_bf16 v[80:83], v[22:25], v[240:243], v[80:83]
    v_mfma_f32_16x16x32_bf16 v[36:39], v[24:27], v[196:199], v[36:39]
    v_mfma_f32_16x16x32_bf16 v[52:55], v[22:25], v[196:199], v[52:55]
    v_mfma_f32_16x16x32_bf16 v[68:71], v[24:27], v[244:247], v[68:71]
    v_mfma_f32_16x16x32_bf16 v[84:87], v[22:25], v[244:247], v[84:87]
    v_mfma_f32_16x16x32_bf16 v[40:43], v[24:27], v[200:203], v[40:43]
    v_mfma_f32_16x16x32_bf16 v[56:59], v[22:25], v[200:203], v[56:59]
    v_mfma_f32_16x16x32_bf16 v[72:75], v[24:27], v[248:251], v[72:75]
    v_mfma_f32_16x16x32_bf16 v[88:91], v[22:25], v[248:251], v[88:91]
    s_lshl_b32 s40, s23, 5
    s_lshl_b32 s41, s22, 2
    s_add_u32 s40, s40, s41
    s_lshl_b32 s41, s30, 1
    s_add_u32 s40, s40, s41
    s_lshl_b32 s40, s40, 13
    s_lshl_b32 s42, s31, 12
    s_add_u32 s40, s40, s42
    s_add_u32 s41, s40, 8192
    s_mov_b32 s43, s33
    s_add_u32 s43, s43, 49152
    s_cmp_eq_u32 s43, 147456
    s_cselect_b32 s43, 0, s43
    s_cmp_eq_u32 s30, 0
    s_cselect_b32 s43, s33, s43
    s_add_u32 s43, s43, s42
    v_and_b32 v3, 0x33, v2
    v_lshrrev_b32 v4, 1, v2
    v_and_b32 v4, 4, v4
    v_or_b32 v3, v3, v4
    v_lshlrev_b32 v3, 4, v3
    v_and_b32 v4, 4, v2
    v_lshlrev_b32 v4, 8, v4
    v_or_b32 v3, v3, v4
    v_add_u32 v4, s43, v3
    v_cvt_pk_bf16_f32 v156, v28, v29
    v_cvt_pk_bf16_f32 v157, v30, v31
    v_cvt_pk_bf16_f32 v158, v44, v45
    v_cvt_pk_bf16_f32 v159, v46, v47
    buffer_store_dwordx4 v[156:159], v3, s[16:19], s40 offen offset:0 sc1
    ds_write_b128 v4, v[156:159] offset:0
    v_cvt_pk_bf16_f32 v160, v32, v33
    v_cvt_pk_bf16_f32 v161, v34, v35
    v_cvt_pk_bf16_f32 v162, v48, v49
    v_cvt_pk_bf16_f32 v163, v50, v51
    buffer_store_dwordx4 v[160:163], v3, s[16:19], s40 offen offset:128 sc1
    ds_write_b128 v4, v[160:163] offset:128
    v_cvt_pk_bf16_f32 v164, v36, v37
    v_cvt_pk_bf16_f32 v165, v38, v39
    v_cvt_pk_bf16_f32 v166, v52, v53
    v_cvt_pk_bf16_f32 v167, v54, v55
    buffer_store_dwordx4 v[164:167], v3, s[16:19], s40 offen offset:2048 sc1
    ds_write_b128 v4, v[164:167] offset:2048
    v_cvt_pk_bf16_f32 v168, v40, v41
    v_cvt_pk_bf16_f32 v169, v42, v43
    v_cvt_pk_bf16_f32 v170, v56, v57
    v_cvt_pk_bf16_f32 v171, v58, v59
    buffer_store_dwordx4 v[168:171], v3, s[16:19], s40 offen offset:2176 sc1
    ds_write_b128 v4, v[168:171] offset:2176
    v_cvt_pk_bf16_f32 v172, v60, v61
    v_cvt_pk_bf16_f32 v173, v62, v63
    v_cvt_pk_bf16_f32 v174, v76, v77
    v_cvt_pk_bf16_f32 v175, v78, v79
    buffer_store_dwordx4 v[172:175], v3, s[16:19], s41 offen offset:0 sc1
    ds_write_b128 v4, v[172:175] offset:8192
    v_cvt_pk_bf16_f32 v176, v64, v65
    v_cvt_pk_bf16_f32 v177, v66, v67
    v_cvt_pk_bf16_f32 v178, v80, v81
    v_cvt_pk_bf16_f32 v179, v82, v83
    buffer_store_dwordx4 v[176:179], v3, s[16:19], s41 offen offset:128 sc1
    ds_write_b128 v4, v[176:179] offset:8320
    v_cvt_pk_bf16_f32 v180, v68, v69
    v_cvt_pk_bf16_f32 v181, v70, v71
    v_cvt_pk_bf16_f32 v182, v84, v85
    v_cvt_pk_bf16_f32 v183, v86, v87
    buffer_store_dwordx4 v[180:183], v3, s[16:19], s41 offen offset:2048 sc1
    ds_write_b128 v4, v[180:183] offset:10240
    v_cvt_pk_bf16_f32 v184, v72, v73
    v_cvt_pk_bf16_f32 v185, v74, v75
    v_cvt_pk_bf16_f32 v186, v88, v89
    v_cvt_pk_bf16_f32 v187, v90, v91
    buffer_store_dwordx4 v[184:187], v3, s[16:19], s41 offen offset:2176 sc1
    ds_write_b128 v4, v[184:187] offset:10368
    v_mov_b64 v[28:29], 0
    v_mov_b64 v[30:31], 0
    v_mov_b64 v[32:33], 0
    v_mov_b64 v[34:35], 0
    v_mov_b64 v[36:37], 0
    v_mov_b64 v[38:39], 0
    v_mov_b64 v[40:41], 0
    v_mov_b64 v[42:43], 0
    v_mov_b64 v[44:45], 0
    v_mov_b64 v[46:47], 0
    v_mov_b64 v[48:49], 0
    v_mov_b64 v[50:51], 0
    v_mov_b64 v[52:53], 0
    v_mov_b64 v[54:55], 0
    v_mov_b64 v[56:57], 0
    v_mov_b64 v[58:59], 0
    v_mov_b64 v[60:61], 0
    v_mov_b64 v[62:63], 0
    v_mov_b64 v[64:65], 0
    v_mov_b64 v[66:67], 0
    v_mov_b64 v[68:69], 0
    v_mov_b64 v[70:71], 0
    v_mov_b64 v[72:73], 0
    v_mov_b64 v[74:75], 0
    v_mov_b64 v[76:77], 0
    v_mov_b64 v[78:79], 0
    v_mov_b64 v[80:81], 0
    v_mov_b64 v[82:83], 0
    v_mov_b64 v[84:85], 0
    v_mov_b64 v[86:87], 0
    v_mov_b64 v[88:89], 0
    v_mov_b64 v[90:91], 0
    s_mov_b32 s16, s72
    s_mov_b32 s17, s73
    s_mov_b32 s18, 14680064
    s_mov_b32 s19, 0x20000
    v_lshlrev_b32 v16, 4, v2
    s_lshl_b32 s26, s25, 12
    s_add_u32 s26, s26, 16384
    v_add_u32 v17, s26, v16
    s_waitcnt lgkmcnt(0)
    v_add_u32 v9, s33, v17
    v_add_u32 v8, s33, v16
    s_barrier
    ds_read_b128 v[188:191], v9 offset:0
    ds_read_b128 v[192:195], v9 offset:1024
    ds_read_b128 v[196:199], v9 offset:2048
    ds_read_b128 v[200:203], v9 offset:3072
    ds_read_b128 v[156:159], v8 offset:0
    ds_read_b128 v[160:163], v8 offset:1024
    ds_read_b128 v[164:167], v8 offset:2048
    ds_read_b128 v[168:171], v8 offset:3072
    ds_read_b128 v[172:175], v8 offset:4096
    ds_read_b128 v[176:179], v8 offset:5120
    ds_read_b128 v[180:183], v8 offset:6144
    ds_read_b128 v[184:187], v8 offset:7168
    s_mov_b32 s36, 13
    s_branch L_gc_mid
L_gc_top:
    v_mfma_f32_16x16x32_bf16 v[28:31], v[204:207], v[236:239], v[28:31]
    v_mfma_f32_16x16x32_bf16 v[32:35], v[204:207], v[240:243], v[32:35]
    s_barrier
    ds_read_b128 v[188:191], v9 offset:0
    v_mfma_f32_16x16x32_bf16 v[36:39], v[204:207], v[244:247], v[36:39]
    ds_read_b128 v[192:195], v9 offset:1024
    v_mfma_f32_16x16x32_bf16 v[40:43], v[204:207], v[248:251], v[40:43]
    ds_read_b128 v[196:199], v9 offset:2048
    v_mfma_f32_16x16x32_bf16 v[56:59], v[208:211], v[248:251], v[56:59]
    ds_read_b128 v[200:203], v9 offset:3072
    v_mfma_f32_16x16x32_bf16 v[52:55], v[208:211], v[244:247], v[52:55]
    ds_read_b128 v[156:159], v8 offset:0
    v_mfma_f32_16x16x32_bf16 v[48:51], v[208:211], v[240:243], v[48:51]
    ds_read_b128 v[160:163], v8 offset:1024
    v_mfma_f32_16x16x32_bf16 v[44:47], v[208:211], v[236:239], v[44:47]
    ds_read_b128 v[164:167], v8 offset:2048
    v_mfma_f32_16x16x32_bf16 v[60:63], v[212:215], v[236:239], v[60:63]
    ds_read_b128 v[168:171], v8 offset:3072
    v_mfma_f32_16x16x32_bf16 v[64:67], v[212:215], v[240:243], v[64:67]
    ds_read_b128 v[172:175], v8 offset:4096
    v_mfma_f32_16x16x32_bf16 v[68:71], v[212:215], v[244:247], v[68:71]
    ds_read_b128 v[176:179], v8 offset:5120
    v_mfma_f32_16x16x32_bf16 v[72:75], v[212:215], v[248:251], v[72:75]
    ds_read_b128 v[180:183], v8 offset:6144
    v_mfma_f32_16x16x32_bf16 v[88:91], v[216:219], v[248:251], v[88:91]
    ds_read_b128 v[184:187], v8 offset:7168
    v_mfma_f32_16x16x32_bf16 v[84:87], v[216:219], v[244:247], v[84:87]
    v_mfma_f32_16x16x32_bf16 v[80:83], v[216:219], v[240:243], v[80:83]
    v_mfma_f32_16x16x32_bf16 v[76:79], v[216:219], v[236:239], v[76:79]
    v_mfma_f32_16x16x32_bf16 v[92:95], v[220:223], v[236:239], v[92:95]
    v_mfma_f32_16x16x32_bf16 v[96:99], v[220:223], v[240:243], v[96:99]
    v_mfma_f32_16x16x32_bf16 v[100:103], v[220:223], v[244:247], v[100:103]
    v_mfma_f32_16x16x32_bf16 v[104:107], v[220:223], v[248:251], v[104:107]
    v_mfma_f32_16x16x32_bf16 v[120:123], v[224:227], v[248:251], v[120:123]
    v_mfma_f32_16x16x32_bf16 v[116:119], v[224:227], v[244:247], v[116:119]
    v_mfma_f32_16x16x32_bf16 v[112:115], v[224:227], v[240:243], v[112:115]
    v_mfma_f32_16x16x32_bf16 v[108:111], v[224:227], v[236:239], v[108:111]
    v_mfma_f32_16x16x32_bf16 v[124:127], v[228:231], v[236:239], v[124:127]
    v_mfma_f32_16x16x32_bf16 v[128:131], v[228:231], v[240:243], v[128:131]
    v_mfma_f32_16x16x32_bf16 v[132:135], v[228:231], v[244:247], v[132:135]
    v_mfma_f32_16x16x32_bf16 v[136:139], v[228:231], v[248:251], v[136:139]
    v_mfma_f32_16x16x32_bf16 v[152:155], v[232:235], v[248:251], v[152:155]
    v_mfma_f32_16x16x32_bf16 v[148:151], v[232:235], v[244:247], v[148:151]
    v_mfma_f32_16x16x32_bf16 v[144:147], v[232:235], v[240:243], v[144:147]
    v_mfma_f32_16x16x32_bf16 v[140:143], v[232:235], v[236:239], v[140:143]
L_gc_mid:
    s_waitcnt lgkmcnt(0)
    v_mfma_f32_16x16x32_bf16 v[28:31], v[156:159], v[188:191], v[28:31]
    ds_read_b128 v[236:239], v9 offset:16384
    s_add_u32 s33, s33, 49152
    v_mfma_f32_16x16x32_bf16 v[32:35], v[156:159], v[192:195], v[32:35]
    ds_read_b128 v[240:243], v9 offset:17408
    s_cmp_eq_u32 s33, 147456
    v_mfma_f32_16x16x32_bf16 v[36:39], v[156:159], v[196:199], v[36:39]
    ds_read_b128 v[244:247], v9 offset:18432
    s_cselect_b32 s33, 0, s33
    v_mfma_f32_16x16x32_bf16 v[40:43], v[156:159], v[200:203], v[40:43]
    ds_read_b128 v[248:251], v9 offset:19456
    v_add_u32 v9, s33, v17
    s_sub_u32 s36, s36, 1
    v_mfma_f32_16x16x32_bf16 v[56:59], v[160:163], v[200:203], v[56:59]
    ds_read_b128 v[204:207], v8 offset:8192
    s_cmp_lg_u32 s36, 0
    v_mfma_f32_16x16x32_bf16 v[52:55], v[160:163], v[196:199], v[52:55]
    ds_read_b128 v[208:211], v8 offset:9216
    v_mfma_f32_16x16x32_bf16 v[48:51], v[160:163], v[192:195], v[48:51]
    ds_read_b128 v[212:215], v8 offset:10240
    v_mfma_f32_16x16x32_bf16 v[44:47], v[160:163], v[188:191], v[44:47]
    ds_read_b128 v[216:219], v8 offset:11264
    v_mfma_f32_16x16x32_bf16 v[60:63], v[164:167], v[188:191], v[60:63]
    ds_read_b128 v[220:223], v8 offset:12288
    v_mfma_f32_16x16x32_bf16 v[64:67], v[164:167], v[192:195], v[64:67]
    ds_read_b128 v[224:227], v8 offset:13312
    v_mfma_f32_16x16x32_bf16 v[68:71], v[164:167], v[196:199], v[68:71]
    ds_read_b128 v[228:231], v8 offset:14336
    v_mfma_f32_16x16x32_bf16 v[72:75], v[164:167], v[200:203], v[72:75]
    ds_read_b128 v[232:235], v8 offset:15360
    v_add_u32 v8, s33, v16
    v_mfma_f32_16x16x32_bf16 v[88:91], v[168:171], v[200:203], v[88:91]
    v_mfma_f32_16x16x32_bf16 v[84:87], v[168:171], v[196:199], v[84:87]
    v_mfma_f32_16x16x32_bf16 v[80:83], v[168:171], v[192:195], v[80:83]
    v_mfma_f32_16x16x32_bf16 v[76:79], v[168:171], v[188:191], v[76:79]
    v_mfma_f32_16x16x32_bf16 v[92:95], v[172:175], v[188:191], v[92:95]
    v_mfma_f32_16x16x32_bf16 v[96:99], v[172:175], v[192:195], v[96:99]
    v_mfma_f32_16x16x32_bf16 v[100:103], v[172:175], v[196:199], v[100:103]
    v_mfma_f32_16x16x32_bf16 v[104:107], v[172:175], v[200:203], v[104:107]
    v_mfma_f32_16x16x32_bf16 v[120:123], v[176:179], v[200:203], v[120:123]
    v_mfma_f32_16x16x32_bf16 v[116:119], v[176:179], v[196:199], v[116:119]
    v_mfma_f32_16x16x32_bf16 v[112:115], v[176:179], v[192:195], v[112:115]
    v_mfma_f32_16x16x32_bf16 v[108:111], v[176:179], v[188:191], v[108:111]
    v_mfma_f32_16x16x32_bf16 v[124:127], v[180:183], v[188:191], v[124:127]
    v_mfma_f32_16x16x32_bf16 v[128:131], v[180:183], v[192:195], v[128:131]
    v_mfma_f32_16x16x32_bf16 v[132:135], v[180:183], v[196:199], v[132:135]
    v_mfma_f32_16x16x32_bf16 v[136:139], v[180:183], v[200:203], v[136:139]
    v_mfma_f32_16x16x32_bf16 v[152:155], v[184:187], v[200:203], v[152:155]
    v_mfma_f32_16x16x32_bf16 v[148:151], v[184:187], v[196:199], v[148:151]
    v_mfma_f32_16x16x32_bf16 v[144:147], v[184:187], v[192:195], v[144:147]
    v_mfma_f32_16x16x32_bf16 v[140:143], v[184:187], v[188:191], v[140:143]
    s_waitcnt vmcnt(0) lgkmcnt(0)
    s_cbranch_scc1 L_gc_top
    s_add_u32 s33, s33, 49152
    s_cmp_eq_u32 s33, 147456
    s_cselect_b32 s33, 0, s33
    v_add_u32 v10, s33, v16
    v_add_u32 v11, s33, v17
    s_add_u32 s33, s33, 49152
    s_cmp_eq_u32 s33, 147456
    s_cselect_b32 s33, 0, s33
    v_add_u32 v12, s33, v16
    v_add_u32 v13, s33, v17
    v_mfma_f32_16x16x32_bf16 v[28:31], v[204:207], v[236:239], v[28:31]
    v_mfma_f32_16x16x32_bf16 v[32:35], v[204:207], v[240:243], v[32:35]
    s_barrier
    ds_read_b128 v[172:175], v9 offset:0
    v_mfma_f32_16x16x32_bf16 v[36:39], v[204:207], v[244:247], v[36:39]
    ds_read_b128 v[156:159], v8 offset:0
    v_mfma_f32_16x16x32_bf16 v[40:43], v[204:207], v[248:251], v[40:43]
    ds_read_b128 v[176:179], v9 offset:1024
    v_mfma_f32_16x16x32_bf16 v[56:59], v[208:211], v[248:251], v[56:59]
    ds_read_b128 v[160:163], v8 offset:1024
    v_mfma_f32_16x16x32_bf16 v[52:55], v[208:211], v[244:247], v[52:55]
    ds_read_b128 v[180:183], v9 offset:2048
    v_mfma_f32_16x16x32_bf16 v[48:51], v[208:211], v[240:243], v[48:51]
    ds_read_b128 v[164:167], v8 offset:2048
    v_mfma_f32_16x16x32_bf16 v[44:47], v[208:211], v[236:239], v[44:47]
    ds_read_b128 v[184:187], v9 offset:3072
    v_mfma_f32_16x16x32_bf16 v[60:63], v[212:215], v[236:239], v[60:63]
    ds_read_b128 v[168:171], v8 offset:3072
    v_mfma_f32_16x16x32_bf16 v[64:67], v[212:215], v[240:243], v[64:67]
    v_mfma_f32_16x16x32_bf16 v[68:71], v[212:215], v[244:247], v[68:71]
    v_mfma_f32_16x16x32_bf16 v[72:75], v[212:215], v[248:251], v[72:75]
    v_mfma_f32_16x16x32_bf16 v[88:91], v[216:219], v[248:251], v[88:91]
    v_mfma_f32_16x16x32_bf16 v[84:87], v[216:219], v[244:247], v[84:87]
    v_mfma_f32_16x16x32_bf16 v[80:83], v[216:219], v[240:243], v[80:83]
    v_mfma_f32_16x16x32_bf16 v[76:79], v[216:219], v[236:239], v[76:79]
    v_mfma_f32_16x16x32_bf16 v[92:95], v[220:223], v[236:239], v[92:95]
    v_mfma_f32_16x16x32_bf16 v[96:99], v[220:223], v[240:243], v[96:99]
    v_mfma_f32_16x16x32_bf16 v[100:103], v[220:223], v[244:247], v[100:103]
    v_mfma_f32_16x16x32_bf16 v[104:107], v[220:223], v[248:251], v[104:107]
    v_mfma_f32_16x16x32_bf16 v[120:123], v[224:227], v[248:251], v[120:123]
    v_mfma_f32_16x16x32_bf16 v[116:119], v[224:227], v[244:247], v[116:119]
    v_mfma_f32_16x16x32_bf16 v[112:115], v[224:227], v[240:243], v[112:115]
    v_mfma_f32_16x16x32_bf16 v[108:111], v[224:227], v[236:239], v[108:111]
    v_mfma_f32_16x16x32_bf16 v[124:127], v[228:231], v[236:239], v[124:127]
    v_mfma_f32_16x16x32_bf16 v[128:131], v[228:231], v[240:243], v[128:131]
    v_mfma_f32_16x16x32_bf16 v[132:135], v[228:231], v[244:247], v[132:135]
    v_mfma_f32_16x16x32_bf16 v[136:139], v[228:231], v[248:251], v[136:139]
    v_mfma_f32_16x16x32_bf16 v[152:155], v[232:235], v[248:251], v[152:155]
    v_mfma_f32_16x16x32_bf16 v[148:151], v[232:235], v[244:247], v[148:151]
    v_mfma_f32_16x16x32_bf16 v[144:147], v[232:235], v[240:243], v[144:147]
    v_mfma_f32_16x16x32_bf16 v[140:143], v[232:235], v[236:239], v[140:143]
    s_waitcnt lgkmcnt(0)
    v_mfma_f32_16x16x32_bf16 v[28:31], v[156:159], v[172:175], v[28:31]
    ds_read_b128 v[220:223], v9 offset:16384
    v_mfma_f32_16x16x32_bf16 v[32:35], v[156:159], v[176:179], v[32:35]
    ds_read_b128 v[204:207], v8 offset:8192
    v_mfma_f32_16x16x32_bf16 v[36:39], v[156:159], v[180:183], v[36:39]
    ds_read_b128 v[224:227], v9 offset:17408
    v_mfma_f32_16x16x32_bf16 v[40:43], v[156:159], v[184:187], v[40:43]
    ds_read_b128 v[208:211], v8 offset:9216
    v_mfma_f32_16x16x32_bf16 v[56:59], v[160:163], v[184:187], v[56:59]
    ds_read_b128 v[228:231], v9 offset:18432
    v_mfma_f32_16x16x32_bf16 v[52:55], v[160:163], v[180:183], v[52:55]
    ds_read_b128 v[212:215], v8 offset:10240
    v_mfma_f32_16x16x32_bf16 v[48:51], v[160:163], v[176:179], v[48:51]
    ds_read_b128 v[232:235], v9 offset:19456
    v_mfma_f32_16x16x32_bf16 v[44:47], v[160:163], v[172:175], v[44:47]
    ds_read_b128 v[216:219], v8 offset:11264
    v_mfma_f32_16x16x32_bf16 v[60:63], v[164:167], v[172:175], v[60:63]
    v_mfma_f32_16x16x32_bf16 v[64:67], v[164:167], v[176:179], v[64:67]
    v_mfma_f32_16x16x32_bf16 v[68:71], v[164:167], v[180:183], v[68:71]
    v_mfma_f32_16x16x32_bf16 v[72:75], v[164:167], v[184:187], v[72:75]
    v_mfma_f32_16x16x32_bf16 v[88:91], v[168:171], v[184:187], v[88:91]
    v_mfma_f32_16x16x32_bf16 v[84:87], v[168:171], v[180:183], v[84:87]
    v_mfma_f32_16x16x32_bf16 v[80:83], v[168:171], v[176:179], v[80:83]
    v_mfma_f32_16x16x32_bf16 v[76:79], v[168:171], v[172:175], v[76:79]
    s_waitcnt lgkmcnt(0)
    v_mfma_f32_16x16x32_bf16 v[28:31], v[204:207], v[220:223], v[28:31]
    v_mfma_f32_16x16x32_bf16 v[32:35], v[204:207], v[224:227], v[32:35]
    s_barrier
    ds_read_b128 v[172:175], v11 offset:0
    v_mfma_f32_16x16x32_bf16 v[36:39], v[204:207], v[228:231], v[36:39]
    ds_read_b128 v[156:159], v10 offset:0
    v_mfma_f32_16x16x32_bf16 v[40:43], v[204:207], v[232:235], v[40:43]
    ds_read_b128 v[176:179], v11 offset:1024
    v_mfma_f32_16x16x32_bf16 v[56:59], v[208:211], v[232:235], v[56:59]
    ds_read_b128 v[160:163], v10 offset:1024
    v_mfma_f32_16x16x32_bf16 v[52:55], v[208:211], v[228:231], v[52:55]
    ds_read_b128 v[180:183], v11 offset:2048
    v_mfma_f32_16x16x32_bf16 v[48:51], v[208:211], v[224:227], v[48:51]
    ds_read_b128 v[164:167], v10 offset:2048
    v_mfma_f32_16x16x32_bf16 v[44:47], v[208:211], v[220:223], v[44:47]
    ds_read_b128 v[184:187], v11 offset:3072
    v_mfma_f32_16x16x32_bf16 v[60:63], v[212:215], v[220:223], v[60:63]
    ds_read_b128 v[168:171], v10 offset:3072
    v_mfma_f32_16x16x32_bf16 v[64:67], v[212:215], v[224:227], v[64:67]
    v_mfma_f32_16x16x32_bf16 v[68:71], v[212:215], v[228:231], v[68:71]
    v_mfma_f32_16x16x32_bf16 v[72:75], v[212:215], v[232:235], v[72:75]
    v_mfma_f32_16x16x32_bf16 v[88:91], v[216:219], v[232:235], v[88:91]
    v_mfma_f32_16x16x32_bf16 v[84:87], v[216:219], v[228:231], v[84:87]
    v_mfma_f32_16x16x32_bf16 v[80:83], v[216:219], v[224:227], v[80:83]
    v_mfma_f32_16x16x32_bf16 v[76:79], v[216:219], v[220:223], v[76:79]
    s_waitcnt lgkmcnt(0)
    v_mfma_f32_16x16x32_bf16 v[28:31], v[156:159], v[172:175], v[28:31]
    ds_read_b128 v[220:223], v11 offset:16384
    v_mfma_f32_16x16x32_bf16 v[32:35], v[156:159], v[176:179], v[32:35]
    ds_read_b128 v[204:207], v10 offset:8192
    v_mfma_f32_16x16x32_bf16 v[36:39], v[156:159], v[180:183], v[36:39]
    ds_read_b128 v[224:227], v11 offset:17408
    v_mfma_f32_16x16x32_bf16 v[40:43], v[156:159], v[184:187], v[40:43]
    ds_read_b128 v[208:211], v10 offset:9216
    v_mfma_f32_16x16x32_bf16 v[56:59], v[160:163], v[184:187], v[56:59]
    ds_read_b128 v[228:231], v11 offset:18432
    v_mfma_f32_16x16x32_bf16 v[52:55], v[160:163], v[180:183], v[52:55]
    ds_read_b128 v[212:215], v10 offset:10240
    v_mfma_f32_16x16x32_bf16 v[48:51], v[160:163], v[176:179], v[48:51]
    ds_read_b128 v[232:235], v11 offset:19456
    v_mfma_f32_16x16x32_bf16 v[44:47], v[160:163], v[172:175], v[44:47]
    ds_read_b128 v[216:219], v10 offset:11264
    v_mfma_f32_16x16x32_bf16 v[60:63], v[164:167], v[172:175], v[60:63]
    v_mfma_f32_16x16x32_bf16 v[64:67], v[164:167], v[176:179], v[64:67]
    v_mfma_f32_16x16x32_bf16 v[68:71], v[164:167], v[180:183], v[68:71]
    v_mfma_f32_16x16x32_bf16 v[72:75], v[164:167], v[184:187], v[72:75]
    v_mfma_f32_16x16x32_bf16 v[88:91], v[168:171], v[184:187], v[88:91]
    v_mfma_f32_16x16x32_bf16 v[84:87], v[168:171], v[180:183], v[84:87]
    v_mfma_f32_16x16x32_bf16 v[80:83], v[168:171], v[176:179], v[80:83]
    v_mfma_f32_16x16x32_bf16 v[76:79], v[168:171], v[172:175], v[76:79]
    s_waitcnt lgkmcnt(0)
    v_mfma_f32_16x16x32_bf16 v[28:31], v[204:207], v[220:223], v[28:31]
    v_mfma_f32_16x16x32_bf16 v[32:35], v[204:207], v[224:227], v[32:35]
    s_barrier
    ds_read_b128 v[172:175], v13 offset:0
    v_mfma_f32_16x16x32_bf16 v[36:39], v[204:207], v[228:231], v[36:39]
    ds_read_b128 v[156:159], v12 offset:0
    v_mfma_f32_16x16x32_bf16 v[40:43], v[204:207], v[232:235], v[40:43]
    ds_read_b128 v[176:179], v13 offset:1024
    v_mfma_f32_16x16x32_bf16 v[56:59], v[208:211], v[232:235], v[56:59]
    ds_read_b128 v[160:163], v12 offset:1024
    v_mfma_f32_16x16x32_bf16 v[52:55], v[208:211], v[228:231], v[52:55]
    ds_read_b128 v[180:183], v13 offset:2048
    v_mfma_f32_16x16x32_bf16 v[48:51], v[208:211], v[224:227], v[48:51]
    ds_read_b128 v[164:167], v12 offset:2048
    v_mfma_f32_16x16x32_bf16 v[44:47], v[208:211], v[220:223], v[44:47]
    ds_read_b128 v[184:187], v13 offset:3072
    v_mfma_f32_16x16x32_bf16 v[60:63], v[212:215], v[220:223], v[60:63]
    ds_read_b128 v[168:171], v12 offset:3072
    v_mfma_f32_16x16x32_bf16 v[64:67], v[212:215], v[224:227], v[64:67]
    v_mfma_f32_16x16x32_bf16 v[68:71], v[212:215], v[228:231], v[68:71]
    v_mfma_f32_16x16x32_bf16 v[72:75], v[212:215], v[232:235], v[72:75]
    v_mfma_f32_16x16x32_bf16 v[88:91], v[216:219], v[232:235], v[88:91]
    v_mfma_f32_16x16x32_bf16 v[84:87], v[216:219], v[228:231], v[84:87]
    v_mfma_f32_16x16x32_bf16 v[80:83], v[216:219], v[224:227], v[80:83]
    v_mfma_f32_16x16x32_bf16 v[76:79], v[216:219], v[220:223], v[76:79]
    s_waitcnt lgkmcnt(0)
    v_mfma_f32_16x16x32_bf16 v[28:31], v[156:159], v[172:175], v[28:31]
    ds_read_b128 v[220:223], v13 offset:16384
    v_mfma_f32_16x16x32_bf16 v[32:35], v[156:159], v[176:179], v[32:35]
    ds_read_b128 v[204:207], v12 offset:8192
    v_mfma_f32_16x16x32_bf16 v[36:39], v[156:159], v[180:183], v[36:39]
    ds_read_b128 v[224:227], v13 offset:17408
    v_mfma_f32_16x16x32_bf16 v[40:43], v[156:159], v[184:187], v[40:43]
    ds_read_b128 v[208:211], v12 offset:9216
    v_mfma_f32_16x16x32_bf16 v[56:59], v[160:163], v[184:187], v[56:59]
    ds_read_b128 v[228:231], v13 offset:18432
    v_mfma_f32_16x16x32_bf16 v[52:55], v[160:163], v[180:183], v[52:55]
    ds_read_b128 v[212:215], v12 offset:10240
    v_mfma_f32_16x16x32_bf16 v[48:51], v[160:163], v[176:179], v[48:51]
    ds_read_b128 v[232:235], v13 offset:19456
    v_mfma_f32_16x16x32_bf16 v[44:47], v[160:163], v[172:175], v[44:47]
    ds_read_b128 v[216:219], v12 offset:11264
    v_mfma_f32_16x16x32_bf16 v[60:63], v[164:167], v[172:175], v[60:63]
    v_mfma_f32_16x16x32_bf16 v[64:67], v[164:167], v[176:179], v[64:67]
    v_mfma_f32_16x16x32_bf16 v[68:71], v[164:167], v[180:183], v[68:71]
    v_mfma_f32_16x16x32_bf16 v[72:75], v[164:167], v[184:187], v[72:75]
    v_mfma_f32_16x16x32_bf16 v[88:91], v[168:171], v[184:187], v[88:91]
    v_mfma_f32_16x16x32_bf16 v[84:87], v[168:171], v[180:183], v[84:87]
    v_mfma_f32_16x16x32_bf16 v[80:83], v[168:171], v[176:179], v[80:83]
    v_mfma_f32_16x16x32_bf16 v[76:79], v[168:171], v[172:175], v[76:79]
    s_waitcnt lgkmcnt(0)
    v_mfma_f32_16x16x32_bf16 v[28:31], v[204:207], v[220:223], v[28:31]
    ds_read_b128 v[172:175], v9 offset:0
    v_mfma_f32_16x16x32_bf16 v[32:35], v[204:207], v[224:227], v[32:35]
    ds_read_b128 v[156:159], v8 offset:4096
    v_mfma_f32_16x16x32_bf16 v[36:39], v[204:207], v[228:231], v[36:39]
    ds_read_b128 v[176:179], v9 offset:1024
    v_mfma_f32_16x16x32_bf16 v[40:43], v[204:207], v[232:235], v[40:43]
    ds_read_b128 v[160:163], v8 offset:5120
    v_mfma_f32_16x16x32_bf16 v[56:59], v[208:211], v[232:235], v[56:59]
    ds_read_b128 v[180:183], v9 offset:2048
    v_mfma_f32_16x16x32_bf16 v[52:55], v[208:211], v[228:231], v[52:55]
    ds_read_b128 v[164:167], v8 offset:6144
    v_mfma_f32_16x16x32_bf16 v[48:51], v[208:211], v[224:227], v[48:51]
    ds_read_b128 v[184:187], v9 offset:3072
    v_mfma_f32_16x16x32_bf16 v[44:47], v[208:211], v[220:223], v[44:47]
    ds_read_b128 v[168:171], v8 offset:7168
    v_mfma_f32_16x16x32_bf16 v[60:63], v[212:215], v[220:223], v[60:63]
    v_mfma_f32_16x16x32_bf16 v[64:67], v[212:215], v[224:227], v[64:67]
    v_mfma_f32_16x16x32_bf16 v[68:71], v[212:215], v[228:231], v[68:71]
    v_mfma_f32_16x16x32_bf16 v[72:75], v[212:215], v[232:235], v[72:75]
    v_mfma_f32_16x16x32_bf16 v[88:91], v[216:219], v[232:235], v[88:91]
    v_mfma_f32_16x16x32_bf16 v[84:87], v[216:219], v[228:231], v[84:87]
    v_mfma_f32_16x16x32_bf16 v[80:83], v[216:219], v[224:227], v[80:83]
    v_mfma_f32_16x16x32_bf16 v[76:79], v[216:219], v[220:223], v[76:79]
    s_waitcnt lgkmcnt(0)
    v_mfma_f32_16x16x32_bf16 v[92:95], v[156:159], v[172:175], v[92:95]
    ds_read_b128 v[220:223], v9 offset:16384
    v_mfma_f32_16x16x32_bf16 v[96:99], v[156:159], v[176:179], v[96:99]
    ds_read_b128 v[204:207], v8 offset:12288
    v_mfma_f32_16x16x32_bf16 v[100:103], v[156:159], v[180:183], v[100:103]
    ds_read_b128 v[224:227], v9 offset:17408
    v_mfma_f32_16x16x32_bf16 v[104:107], v[156:159], v[184:187], v[104:107]
    ds_read_b128 v[208:211], v8 offset:13312
    v_mfma_f32_16x16x32_bf16 v[120:123], v[160:163], v[184:187], v[120:123]
    ds_read_b128 v[228:231], v9 offset:18432
    v_cvt_pk_bf16_f32 v188, v28, v29
    v_mfma_f32_16x16x32_bf16 v[116:119], v[160:163], v[180:183], v[116:119]
    ds_read_b128 v[212:215], v8 offset:14336
    v_cvt_pk_bf16_f32 v189, v30, v31
    v_mfma_f32_16x16x32_bf16 v[112:115], v[160:163], v[176:179], v[112:115]
    ds_read_b128 v[232:235], v9 offset:19456
    v_cvt_pk_bf16_f32 v190, v44, v45
    v_mfma_f32_16x16x32_bf16 v[108:111], v[160:163], v[172:175], v[108:111]
    ds_read_b128 v[216:219], v8 offset:15360
    v_cvt_pk_bf16_f32 v191, v46, v47
    v_mfma_f32_16x16x32_bf16 v[124:127], v[164:167], v[172:175], v[124:127]
    v_cvt_pk_bf16_f32 v192, v60, v61
    v_cvt_pk_bf16_f32 v193, v62, v63
    v_mfma_f32_16x16x32_bf16 v[128:131], v[164:167], v[176:179], v[128:131]
    v_cvt_pk_bf16_f32 v194, v76, v77
    v_cvt_pk_bf16_f32 v195, v78, v79
    v_mfma_f32_16x16x32_bf16 v[132:135], v[164:167], v[180:183], v[132:135]
    v_mov_b32 v196, v188
    v_mov_b32 v197, v189
    v_mfma_f32_16x16x32_bf16 v[136:139], v[164:167], v[184:187], v[136:139]
    v_mov_b32 v198, v190
    v_mov_b32 v199, v191
    v_mfma_f32_16x16x32_bf16 v[152:155], v[168:171], v[184:187], v[152:155]
    v_mov_b32_dpp v188, v192 row_ror:8 row_mask:0xf bank_mask:0xc
    v_mov_b32_dpp v189, v193 row_ror:8 row_mask:0xf bank_mask:0xc
    v_mfma_f32_16x16x32_bf16 v[148:151], v[168:171], v[180:183], v[148:151]
    v_mov_b32_dpp v190, v194 row_ror:8 row_mask:0xf bank_mask:0xc
    v_mov_b32_dpp v191, v195 row_ror:8 row_mask:0xf bank_mask:0xc
    v_mfma_f32_16x16x32_bf16 v[144:147], v[168:171], v[176:179], v[144:147]
    v_mov_b32_dpp v192, v196 row_ror:8 row_mask:0xf bank_mask:0x3
    v_mov_b32_dpp v193, v197 row_ror:8 row_mask:0xf bank_mask:0x3
    v_mfma_f32_16x16x32_bf16 v[140:143], v[168:171], v[172:175], v[140:143]
    v_mov_b32_dpp v194, v198 row_ror:8 row_mask:0xf bank_mask:0x3
    v_mov_b32_dpp v195, v199 row_ror:8 row_mask:0xf bank_mask:0x3
    s_waitcnt lgkmcnt(0)
    v_mfma_f32_16x16x32_bf16 v[92:95], v[204:207], v[220:223], v[92:95]
    ds_read_b128 v[172:175], v11 offset:0
    buffer_store_dwordx4 v[188:191], v14, s[16:19], s44 offen offset:0 sc1
    v_mfma_f32_16x16x32_bf16 v[96:99], v[204:207], v[224:227], v[96:99]
    ds_read_b128 v[156:159], v10 offset:4096
    buffer_store_dwordx4 v[192:195], v15, s[16:19], s44 offen offset:0 sc1
    v_mfma_f32_16x16x32_bf16 v[100:103], v[204:207], v[228:231], v[100:103]
    ds_read_b128 v[176:179], v11 offset:1024
    v_cvt_pk_bf16_f32 v236, v32, v33
    v_mfma_f32_16x16x32_bf16 v[104:107], v[204:207], v[232:235], v[104:107]
    ds_read_b128 v[160:163], v10 offset:5120
    v_cvt_pk_bf16_f32 v237, v34, v35
    v_mfma_f32_16x16x32_bf16 v[120:123], v[208:211], v[232:235], v[120:123]
    ds_read_b128 v[180:183], v11 offset:2048
    v_cvt_pk_bf16_f32 v238, v48, v49
    v_mfma_f32_16x16x32_bf16 v[116:119], v[208:211], v[228:231], v[116:119]
    ds_read_b128 v[164:167], v10 offset:6144
    v_cvt_pk_bf16_f32 v239, v50, v51
    v_mfma_f32_16x16x32_bf16 v[112:115], v[208:211], v[224:227], v[112:115]
    ds_read_b128 v[184:187], v11 offset:3072
    v_cvt_pk_bf16_f32 v240, v64, v65
    v_mfma_f32_16x16x32_bf16 v[108:111], v[208:211], v[220:223], v[108:111]
    ds_read_b128 v[168:171], v10 offset:7168
    v_cvt_pk_bf16_f32 v241, v66, v67
    v_mfma_f32_16x16x32_bf16 v[124:127], v[212:215], v[220:223], v[124:127]
    v_cvt_pk_bf16_f32 v242, v80, v81
    v_cvt_pk_bf16_f32 v243, v82, v83
    v_mfma_f32_16x16x32_bf16 v[128:131], v[212:215], v[224:227], v[128:131]
    v_mov_b32 v244, v236
    v_mov_b32 v245, v237
    v_mfma_f32_16x16x32_bf16 v[132:135], v[212:215], v[228:231], v[132:135]
    v_mov_b32 v246, v238
    v_mov_b32 v247, v239
    v_mfma_f32_16x16x32_bf16 v[136:139], v[212:215], v[232:235], v[136:139]
    v_mov_b32_dpp v236, v240 row_ror:8 row_mask:0xf bank_mask:0xc
    v_mov_b32_dpp v237, v241 row_ror:8 row_mask:0xf bank_mask:0xc
    v_mfma_f32_16x16x32_bf16 v[152:155], v[216:219], v[232:235], v[152:155]
    v_mov_b32_dpp v238, v242 row_ror:8 row_mask:0xf bank_mask:0xc
    v_mov_b32_dpp v239, v243 row_ror:8 row_mask:0xf bank_mask:0xc
    v_mfma_f32_16x16x32_bf16 v[148:151], v[216:219], v[228:231], v[148:151]
    v_mov_b32_dpp v240, v244 row_ror:8 row_mask:0xf bank_mask:0x3
    v_mov_b32_dpp v241, v245 row_ror:8 row_mask:0xf bank_mask:0x3
    v_mfma_f32_16x16x32_bf16 v[144:147], v[216:219], v[224:227], v[144:147]
    v_mov_b32_dpp v242, v246 row_ror:8 row_mask:0xf bank_mask:0x3
    v_mov_b32_dpp v243, v247 row_ror:8 row_mask:0xf bank_mask:0x3
    v_mfma_f32_16x16x32_bf16 v[140:143], v[216:219], v[220:223], v[140:143]
    buffer_store_dwordx4 v[236:239], v14, s[16:19], s45 offen offset:0 sc1
    buffer_store_dwordx4 v[240:243], v15, s[16:19], s45 offen offset:0 sc1
    s_waitcnt lgkmcnt(0)
    v_mfma_f32_16x16x32_bf16 v[92:95], v[156:159], v[172:175], v[92:95]
    ds_read_b128 v[220:223], v11 offset:16384
    v_cvt_pk_bf16_f32 v188, v36, v37
    v_mfma_f32_16x16x32_bf16 v[96:99], v[156:159], v[176:179], v[96:99]
    ds_read_b128 v[204:207], v10 offset:12288
    v_cvt_pk_bf16_f32 v189, v38, v39
    v_mfma_f32_16x16x32_bf16 v[100:103], v[156:159], v[180:183], v[100:103]
    ds_read_b128 v[224:227], v11 offset:17408
    v_cvt_pk_bf16_f32 v190, v52, v53
    v_mfma_f32_16x16x32_bf16 v[104:107], v[156:159], v[184:187], v[104:107]
    ds_read_b128 v[208:211], v10 offset:13312
    v_cvt_pk_bf16_f32 v191, v54, v55
    v_mfma_f32_16x16x32_bf16 v[120:123], v[160:163], v[184:187], v[120:123]
    ds_read_b128 v[228:231], v11 offset:18432
    v_cvt_pk_bf16_f32 v192, v68, v69
    v_mfma_f32_16x16x32_bf16 v[116:119], v[160:163], v[180:183], v[116:119]
    ds_read_b128 v[212:215], v10 offset:14336
    v_cvt_pk_bf16_f32 v193, v70, v71
    v_mfma_f32_16x16x32_bf16 v[112:115], v[160:163], v[176:179], v[112:115]
    ds_read_b128 v[232:235], v11 offset:19456
    v_cvt_pk_bf16_f32 v194, v84, v85
    v_mfma_f32_16x16x32_bf16 v[108:111], v[160:163], v[172:175], v[108:111]
    ds_read_b128 v[216:219], v10 offset:15360
    v_cvt_pk_bf16_f32 v195, v86, v87
    v_mfma_f32_16x16x32_bf16 v[124:127], v[164:167], v[172:175], v[124:127]
    v_mov_b32 v196, v188
    v_mov_b32 v197, v189
    v_mfma_f32_16x16x32_bf16 v[128:131], v[164:167], v[176:179], v[128:131]
    v_mov_b32 v198, v190
    v_mov_b32 v199, v191
    v_mfma_f32_16x16x32_bf16 v[132:135], v[164:167], v[180:183], v[132:135]
    v_mov_b32_dpp v188, v192 row_ror:8 row_mask:0xf bank_mask:0xc
    v_mov_b32_dpp v189, v193 row_ror:8 row_mask:0xf bank_mask:0xc
    v_mfma_f32_16x16x32_bf16 v[136:139], v[164:167], v[184:187], v[136:139]
    v_mov_b32_dpp v190, v194 row_ror:8 row_mask:0xf bank_mask:0xc
    v_mov_b32_dpp v191, v195 row_ror:8 row_mask:0xf bank_mask:0xc
    v_mfma_f32_16x16x32_bf16 v[152:155], v[168:171], v[184:187], v[152:155]
    v_mov_b32_dpp v192, v196 row_ror:8 row_mask:0xf bank_mask:0x3
    v_mov_b32_dpp v193, v197 row_ror:8 row_mask:0xf bank_mask:0x3
    v_mfma_f32_16x16x32_bf16 v[148:151], v[168:171], v[180:183], v[148:151]
    v_mov_b32_dpp v194, v198 row_ror:8 row_mask:0xf bank_mask:0x3
    v_mov_b32_dpp v195, v199 row_ror:8 row_mask:0xf bank_mask:0x3
    v_mfma_f32_16x16x32_bf16 v[144:147], v[168:171], v[176:179], v[144:147]
    buffer_store_dwordx4 v[188:191], v14, s[16:19], s46 offen offset:0 sc1
    buffer_store_dwordx4 v[192:195], v15, s[16:19], s46 offen offset:0 sc1
    v_mfma_f32_16x16x32_bf16 v[140:143], v[168:171], v[172:175], v[140:143]
    v_cvt_pk_bf16_f32 v236, v40, v41
    v_cvt_pk_bf16_f32 v237, v42, v43
    s_waitcnt lgkmcnt(0)
    v_mfma_f32_16x16x32_bf16 v[92:95], v[204:207], v[220:223], v[92:95]
    ds_read_b128 v[172:175], v13 offset:0
    v_cvt_pk_bf16_f32 v238, v56, v57
    v_mfma_f32_16x16x32_bf16 v[96:99], v[204:207], v[224:227], v[96:99]
    ds_read_b128 v[156:159], v12 offset:4096
    v_cvt_pk_bf16_f32 v239, v58, v59
    v_mfma_f32_16x16x32_bf16 v[100:103], v[204:207], v[228:231], v[100:103]
    ds_read_b128 v[176:179], v13 offset:1024
    v_cvt_pk_bf16_f32 v240, v72, v73
    v_mfma_f32_16x16x32_bf16 v[104:107], v[204:207], v[232:235], v[104:107]
    ds_read_b128 v[160:163], v12 offset:5120
    v_cvt_pk_bf16_f32 v241, v74, v75
    v_mfma_f32_16x16x32_bf16 v[120:123], v[208:211], v[232:235], v[120:123]
    ds_read_b128 v[180:183], v13 offset:2048
    v_cvt_pk_bf16_f32 v242, v88, v89
    v_mfma_f32_16x16x32_bf16 v[116:119], v[208:211], v[228:231], v[116:119]
    ds_read_b128 v[164:167], v12 offset:6144
    v_cvt_pk_bf16_f32 v243, v90, v91
    v_mfma_f32_16x16x32_bf16 v[112:115], v[208:211], v[224:227], v[112:115]
    ds_read_b128 v[184:187], v13 offset:3072
    v_mov_b32 v244, v236
    v_mfma_f32_16x16x32_bf16 v[108:111], v[208:211], v[220:223], v[108:111]
    ds_read_b128 v[168:171], v12 offset:7168
    v_mov_b32 v245, v237
    v_mfma_f32_16x16x32_bf16 v[124:127], v[212:215], v[220:223], v[124:127]
    v_mov_b32 v246, v238
    v_mov_b32 v247, v239
    v_mfma_f32_16x16x32_bf16 v[128:131], v[212:215], v[224:227], v[128:131]
    v_mov_b32_dpp v236, v240 row_ror:8 row_mask:0xf bank_mask:0xc
    v_mov_b32_dpp v237, v241 row_ror:8 row_mask:0xf bank_mask:0xc
    v_mfma_f32_16x16x32_bf16 v[132:135], v[212:215], v[228:231], v[132:135]
    v_mov_b32_dpp v238, v242 row_ror:8 row_mask:0xf bank_mask:0xc
    v_mov_b32_dpp v239, v243 row_ror:8 row_mask:0xf bank_mask:0xc
    v_mfma_f32_16x16x32_bf16 v[136:139], v[212:215], v[232:235], v[136:139]
    v_mov_b32_dpp v240, v244 row_ror:8 row_mask:0xf bank_mask:0x3
    v_mov_b32_dpp v241, v245 row_ror:8 row_mask:0xf bank_mask:0x3
    v_mfma_f32_16x16x32_bf16 v[152:155], v[216:219], v[232:235], v[152:155]
    v_mov_b32_dpp v242, v246 row_ror:8 row_mask:0xf bank_mask:0x3
    v_mov_b32_dpp v243, v247 row_ror:8 row_mask:0xf bank_mask:0x3
    v_mfma_f32_16x16x32_bf16 v[148:151], v[216:219], v[228:231], v[148:151]
    buffer_store_dwordx4 v[236:239], v14, s[16:19], s47 offen offset:0 sc1
    buffer_store_dwordx4 v[240:243], v15, s[16:19], s47 offen offset:0 sc1
    v_mfma_f32_16x16x32_bf16 v[144:147], v[216:219], v[224:227], v[144:147]
    v_mfma_f32_16x16x32_bf16 v[140:143], v[216:219], v[220:223], v[140:143]
    s_waitcnt lgkmcnt(0)
    v_mfma_f32_16x16x32_bf16 v[92:95], v[156:159], v[172:175], v[92:95]
    ds_read_b128 v[220:223], v13 offset:16384
    v_mfma_f32_16x16x32_bf16 v[96:99], v[156:159], v[176:179], v[96:99]
    ds_read_b128 v[204:207], v12 offset:12288
    v_mfma_f32_16x16x32_bf16 v[100:103], v[156:159], v[180:183], v[100:103]
    ds_read_b128 v[224:227], v13 offset:17408
    v_mfma_f32_16x16x32_bf16 v[104:107], v[156:159], v[184:187], v[104:107]
    ds_read_b128 v[208:211], v12 offset:13312
    v_mfma_f32_16x16x32_bf16 v[120:123], v[160:163], v[184:187], v[120:123]
    ds_read_b128 v[228:231], v13 offset:18432
    v_mfma_f32_16x16x32_bf16 v[116:119], v[160:163], v[180:183], v[116:119]
    ds_read_b128 v[212:215], v12 offset:14336
    v_mfma_f32_16x16x32_bf16 v[112:115], v[160:163], v[176:179], v[112:115]
    ds_read_b128 v[232:235], v13 offset:19456
    v_mfma_f32_16x16x32_bf16 v[108:111], v[160:163], v[172:175], v[108:111]
    ds_read_b128 v[216:219], v12 offset:15360
    v_mfma_f32_16x16x32_bf16 v[124:127], v[164:167], v[172:175], v[124:127]
    v_mfma_f32_16x16x32_bf16 v[128:131], v[164:167], v[176:179], v[128:131]
    v_mfma_f32_16x16x32_bf16 v[132:135], v[164:167], v[180:183], v[132:135]
    v_mfma_f32_16x16x32_bf16 v[136:139], v[164:167], v[184:187], v[136:139]
    v_mfma_f32_16x16x32_bf16 v[152:155], v[168:171], v[184:187], v[152:155]
    v_mfma_f32_16x16x32_bf16 v[148:151], v[168:171], v[180:183], v[148:151]
    v_mfma_f32_16x16x32_bf16 v[144:147], v[168:171], v[176:179], v[144:147]
    v_mfma_f32_16x16x32_bf16 v[140:143], v[168:171], v[172:175], v[140:143]
    s_waitcnt lgkmcnt(0)
    v_mfma_f32_16x16x32_bf16 v[92:95], v[204:207], v[220:223], v[92:95]
    v_mfma_f32_16x16x32_bf16 v[96:99], v[204:207], v[224:227], v[96:99]
    v_mfma_f32_16x16x32_bf16 v[100:103], v[204:207], v[228:231], v[100:103]
    v_mfma_f32_16x16x32_bf16 v[104:107], v[204:207], v[232:235], v[104:107]
    v_mfma_f32_16x16x32_bf16 v[120:123], v[208:211], v[232:235], v[120:123]
    v_mfma_f32_16x16x32_bf16 v[116:119], v[208:211], v[228:231], v[116:119]
    v_mfma_f32_16x16x32_bf16 v[112:115], v[208:211], v[224:227], v[112:115]
    v_mfma_f32_16x16x32_bf16 v[108:111], v[208:211], v[220:223], v[108:111]
    v_mfma_f32_16x16x32_bf16 v[124:127], v[212:215], v[220:223], v[124:127]
    v_mfma_f32_16x16x32_bf16 v[128:131], v[212:215], v[224:227], v[128:131]
    v_mfma_f32_16x16x32_bf16 v[132:135], v[212:215], v[228:231], v[132:135]
    v_mfma_f32_16x16x32_bf16 v[136:139], v[212:215], v[232:235], v[136:139]
    v_mfma_f32_16x16x32_bf16 v[152:155], v[216:219], v[232:235], v[152:155]
    v_mfma_f32_16x16x32_bf16 v[148:151], v[216:219], v[228:231], v[148:151]
    v_mfma_f32_16x16x32_bf16 v[144:147], v[216:219], v[224:227], v[144:147]
    v_mfma_f32_16x16x32_bf16 v[140:143], v[216:219], v[220:223], v[140:143]
    s_nop 7
    v_cvt_pk_bf16_f32 v156, v92, v93
    v_cvt_pk_bf16_f32 v157, v94, v95
    v_cvt_pk_bf16_f32 v158, v108, v109
    v_cvt_pk_bf16_f32 v159, v110, v111
    v_cvt_pk_bf16_f32 v160, v124, v125
    v_cvt_pk_bf16_f32 v161, v126, v127
    v_cvt_pk_bf16_f32 v162, v140, v141
    v_cvt_pk_bf16_f32 v163, v142, v143
    v_mov_b32 v164, v156
    v_mov_b32 v165, v157
    v_mov_b32 v166, v158
    v_mov_b32 v167, v159
    v_mov_b32_dpp v156, v160 row_ror:8 row_mask:0xf bank_mask:0xc
    v_mov_b32_dpp v157, v161 row_ror:8 row_mask:0xf bank_mask:0xc
    v_mov_b32_dpp v158, v162 row_ror:8 row_mask:0xf bank_mask:0xc
    v_mov_b32_dpp v159, v163 row_ror:8 row_mask:0xf bank_mask:0xc
    v_mov_b32_dpp v160, v164 row_ror:8 row_mask:0xf bank_mask:0x3
    v_mov_b32_dpp v161, v165 row_ror:8 row_mask:0xf bank_mask:0x3
    v_mov_b32_dpp v162, v166 row_ror:8 row_mask:0xf bank_mask:0x3
    v_mov_b32_dpp v163, v167 row_ror:8 row_mask:0xf bank_mask:0x3
    buffer_store_dwordx4 v[156:159], v14, s[16:19], s44 offen offset:128 sc1
    buffer_store_dwordx4 v[160:163], v15, s[16:19], s44 offen offset:128 sc1
    v_cvt_pk_bf16_f32 v168, v96, v97
    v_cvt_pk_bf16_f32 v169, v98, v99
    v_cvt_pk_bf16_f32 v170, v112, v113
    v_cvt_pk_bf16_f32 v171, v114, v115
    v_cvt_pk_bf16_f32 v172, v128, v129
    v_cvt_pk_bf16_f32 v173, v130, v131
    v_cvt_pk_bf16_f32 v174, v144, v145
    v_cvt_pk_bf16_f32 v175, v146, v147
    v_mov_b32 v176, v168
    v_mov_b32 v177, v169
    v_mov_b32 v178, v170
    v_mov_b32 v179, v171
    v_mov_b32_dpp v168, v172 row_ror:8 row_mask:0xf bank_mask:0xc
    v_mov_b32_dpp v169, v173 row_ror:8 row_mask:0xf bank_mask:0xc
    v_mov_b32_dpp v170, v174 row_ror:8 row_mask:0xf bank_mask:0xc
    v_mov_b32_dpp v171, v175 row_ror:8 row_mask:0xf bank_mask:0xc
    v_mov_b32_dpp v172, v176 row_ror:8 row_mask:0xf bank_mask:0x3
    v_mov_b32_dpp v173, v177 row_ror:8 row_mask:0xf bank_mask:0x3
    v_mov_b32_dpp v174, v178 row_ror:8 row_mask:0xf bank_mask:0x3
    v_mov_b32_dpp v175, v179 row_ror:8 row_mask:0xf bank_mask:0x3
    buffer_store_dwordx4 v[168:171], v14, s[16:19], s45 offen offset:128 sc1
    buffer_store_dwordx4 v[172:175], v15, s[16:19], s45 offen offset:128 sc1
    v_cvt_pk_bf16_f32 v204, v100, v101
    v_cvt_pk_bf16_f32 v205, v102, v103
    v_cvt_pk_bf16_f32 v206, v116, v117
    v_cvt_pk_bf16_f32 v207, v118, v119
    v_cvt_pk_bf16_f32 v208, v132, v133
    v_cvt_pk_bf16_f32 v209, v134, v135
    v_cvt_pk_bf16_f32 v210, v148, v149
    v_cvt_pk_bf16_f32 v211, v150, v151
    v_mov_b32 v212, v204
    v_mov_b32 v213, v205
    v_mov_b32 v214, v206
    v_mov_b32 v215, v207
    v_mov_b32_dpp v204, v208 row_ror:8 row_mask:0xf bank_mask:0xc
    v_mov_b32_dpp v205, v209 row_ror:8 row_mask:0xf bank_mask:0xc
    v_mov_b32_dpp v206, v210 row_ror:8 row_mask:0xf bank_mask:0xc
    v_mov_b32_dpp v207, v211 row_ror:8 row_mask:0xf bank_mask:0xc
    v_mov_b32_dpp v208, v212 row_ror:8 row_mask:0xf bank_mask:0x3
    v_mov_b32_dpp v209, v213 row_ror:8 row_mask:0xf bank_mask:0x3
    v_mov_b32_dpp v210, v214 row_ror:8 row_mask:0xf bank_mask:0x3
    v_mov_b32_dpp v211, v215 row_ror:8 row_mask:0xf bank_mask:0x3
    buffer_store_dwordx4 v[204:207], v14, s[16:19], s46 offen offset:128 sc1
    buffer_store_dwordx4 v[208:211], v15, s[16:19], s46 offen offset:128 sc1
    v_cvt_pk_bf16_f32 v216, v104, v105
    v_cvt_pk_bf16_f32 v217, v106, v107
    v_cvt_pk_bf16_f32 v218, v120, v121
    v_cvt_pk_bf16_f32 v219, v122, v123
    v_cvt_pk_bf16_f32 v220, v136, v137
    v_cvt_pk_bf16_f32 v221, v138, v139
    v_cvt_pk_bf16_f32 v222, v152, v153
    v_cvt_pk_bf16_f32 v223, v154, v155
    v_mov_b32 v224, v216
    v_mov_b32 v225, v217
    v_mov_b32 v226, v218
    v_mov_b32 v227, v219
    v_mov_b32_dpp v216, v220 row_ror:8 row_mask:0xf bank_mask:0xc
    v_mov_b32_dpp v217, v221 row_ror:8 row_mask:0xf bank_mask:0xc
    v_mov_b32_dpp v218, v222 row_ror:8 row_mask:0xf bank_mask:0xc
    v_mov_b32_dpp v219, v223 row_ror:8 row_mask:0xf bank_mask:0xc
    v_mov_b32_dpp v220, v224 row_ror:8 row_mask:0xf bank_mask:0x3
    v_mov_b32_dpp v221, v225 row_ror:8 row_mask:0xf bank_mask:0x3
    v_mov_b32_dpp v222, v226 row_ror:8 row_mask:0xf bank_mask:0x3
    v_mov_b32_dpp v223, v227 row_ror:8 row_mask:0xf bank_mask:0x3
    buffer_store_dwordx4 v[216:219], v14, s[16:19], s47 offen offset:128 sc1
    buffer_store_dwordx4 v[220:223], v15, s[16:19], s47 offen offset:128 sc1
    s_endpgm
L_mainp:
    s_sub_u32 s30, s25, 4
    s_lshl_b32 s31, s30, 10
    s_lshl_b32 s32, s30, 12
    s_mov_b32 s8, s70
    s_mov_b32 s9, s71
    s_mov_b32 s10, 25690112
    s_mov_b32 s11, 0x20000
    s_lshl_b32 s27, s23, 8
    v_lshrrev_b32 v3, 4, v2
    v_and_b32 v4, 15, v2
    s_and_b32 s26, s30, 1
    s_lshl_b32 s26, s26, 2
    v_or_b32 v5, s26, v3
    v_lshlrev_b32 v5, 1, v5
    v_xor_b32 v5, v5, v4
    v_lshlrev_b32 v5, 4, v5
    s_lshl_b32 s26, s30, 2
    v_add_u32 v6, s26, v3
    v_mul_u32_u24 v6, 7168, v6
    v_add_u32 v5, v5, v6
    v_add_u32 v8, s27, v5
    v_lshlrev_b32 v5, 4, v2
    v_add_u32 v9, s32, v5
    s_mul_i32 s28, s22, 917504
    s_xor_b32 s29, s22, 1
    s_mul_i32 s29, s29, 917504
    s_and_b32 s53, s20, 1
    s_cselect_b32 s43, 23, 25
    s_mul_i32 s53, s53, 25
    v_min_u32 v13, 27, v2
    v_lshlrev_b32 v13, 7, v13
    s_mov_b32 s59, 0
    s_mov_b32 s55, 11
    s_mov_b32 s52, s43
    s_mov_b32 s40, s62
    s_mov_b32 s41, s63
    s_mov_b32 s42, 14680064
    s_mov_b32 s43, 0x20000
    s_mul_i32 s34, s22, 3584
    s_lshl_b32 s54, s23, 7
    s_add_u32 s54, s54, s34
    s_waitcnt vmcnt(2)
    v_lshlrev_b32 v200, 16, v192
    v_and_b32 v201, 0xffff0000, v192
    v_lshlrev_b32 v208, 16, v196
    v_and_b32 v209, 0xffff0000, v196
    v_lshlrev_b32 v202, 16, v193
    v_and_b32 v203, 0xffff0000, v193
    v_lshlrev_b32 v210, 16, v197
    v_and_b32 v211, 0xffff0000, v197
    v_lshlrev_b32 v204, 16, v194
    v_and_b32 v205, 0xffff0000, v194
    v_lshlrev_b32 v212, 16, v198
    v_and_b32 v213, 0xffff0000, v198
    v_lshlrev_b32 v206, 16, v195
    v_and_b32 v207, 0xffff0000, v195
    v_lshlrev_b32 v214, 16, v199
    v_and_b32 v215, 0xffff0000, v199
    v_cvt_f32_i32 v160, v160
    v_cvt_f32_i32 v161, v161
    v_cvt_f32_i32 v162, v162
    v_cvt_f32_i32 v163, v163
    v_cvt_f32_i32 v164, v164
    v_cvt_f32_i32 v165, v165
    v_cvt_f32_i32 v166, v166
    v_cvt_f32_i32 v167, v167
    v_cvt_pk_bf16_f32 v160, 0, v160
    v_cvt_pk_bf16_f32 v161, 0, v161
    v_cvt_pk_bf16_f32 v162, 0, v162
    v_cvt_pk_bf16_f32 v163, 0, v163
    v_cvt_pk_bf16_f32 v164, 0, v164
    v_cvt_pk_bf16_f32 v165, 0, v165
    v_cvt_pk_bf16_f32 v166, 0, v166
    v_cvt_pk_bf16_f32 v167, 0, v167
    v_sub_f32 v160, v160, v208
    v_sub_f32 v161, v161, v209
    v_sub_f32 v162, v162, v210
    v_sub_f32 v163, v163, v211
    v_sub_f32 v164, v164, v212
    v_sub_f32 v165, v165, v213
    v_sub_f32 v166, v166, v214
    v_sub_f32 v167, v167, v215
    v_cvt_pk_bf16_f32 v160, 0, v160
    v_cvt_pk_bf16_f32 v161, 0, v161
    v_cvt_pk_bf16_f32 v162, 0, v162
    v_cvt_pk_bf16_f32 v163, 0, v163
    v_cvt_pk_bf16_f32 v164, 0, v164
    v_cvt_pk_bf16_f32 v165, 0, v165
    v_cvt_pk_bf16_f32 v166, 0, v166
    v_cvt_pk_bf16_f32 v167, 0, v167
    v_mul_f32 v160, v160, v200
    v_mul_f32 v161, v161, v201
    v_mul_f32 v162, v162, v202
    v_mul_f32 v163, v163, v203
    v_mul_f32 v164, v164, v204
    v_mul_f32 v165, v165, v205
    v_mul_f32 v166, v166, v206
    v_mul_f32 v167, v167, v207
    v_cvt_pk_bf16_f32 v160, v160, v161
    v_cvt_pk_bf16_f32 v161, v162, v163
    v_cvt_pk_bf16_f32 v162, v164, v165
    v_cvt_pk_bf16_f32 v163, v166, v167
    buffer_store_dwordx4 v[160:163], v1, s[12:15], s47 offen offset:0 sc1
    s_waitcnt vmcnt(1)
    v_cvt_f32_i32 v168, v168
    v_cvt_f32_i32 v169, v169
    v_cvt_f32_i32 v170, v170
    v_cvt_f32_i32 v171, v171
    v_cvt_f32_i32 v172, v172
    v_cvt_f32_i32 v173, v173
    v_cvt_f32_i32 v174, v174
    v_cvt_f32_i32 v175, v175
    v_cvt_pk_bf16_f32 v168, 0, v168
    v_cvt_pk_bf16_f32 v169, 0, v169
    v_cvt_pk_bf16_f32 v170, 0, v170
    v_cvt_pk_bf16_f32 v171, 0, v171
    v_cvt_pk_bf16_f32 v172, 0, v172
    v_cvt_pk_bf16_f32 v173, 0, v173
    v_cvt_pk_bf16_f32 v174, 0, v174
    v_cvt_pk_bf16_f32 v175, 0, v175
    v_sub_f32 v168, v168, v208
    v_sub_f32 v169, v169, v209
    v_sub_f32 v170, v170, v210
    v_sub_f32 v171, v171, v211
    v_sub_f32 v172, v172, v212
    v_sub_f32 v173, v173, v213
    v_sub_f32 v174, v174, v214
    v_sub_f32 v175, v175, v215
    v_cvt_pk_bf16_f32 v168, 0, v168
    v_cvt_pk_bf16_f32 v169, 0, v169
    v_cvt_pk_bf16_f32 v170, 0, v170
    v_cvt_pk_bf16_f32 v171, 0, v171
    v_cvt_pk_bf16_f32 v172, 0, v172
    v_cvt_pk_bf16_f32 v173, 0, v173
    v_cvt_pk_bf16_f32 v174, 0, v174
    v_cvt_pk_bf16_f32 v175, 0, v175
    v_mul_f32 v168, v168, v200
    v_mul_f32 v169, v169, v201
    v_mul_f32 v170, v170, v202
    v_mul_f32 v171, v171, v203
    v_mul_f32 v172, v172, v204
    v_mul_f32 v173, v173, v205
    v_mul_f32 v174, v174, v206
    v_mul_f32 v175, v175, v207
    v_cvt_pk_bf16_f32 v168, v168, v169
    v_cvt_pk_bf16_f32 v169, v170, v171
    v_cvt_pk_bf16_f32 v170, v172, v173
    v_cvt_pk_bf16_f32 v171, v174, v175
    buffer_store_dwordx4 v[168:171], v1, s[12:15], s47 offen offset:128 sc1
    s_waitcnt lgkmcnt(0)
    s_mul_i32 s4, s6, 0x9e3779b1
    s_add_u32 s4, s4, 0x7f4a7c15
    s_mul_i32 s5, s7, 0x85ebca6b
    s_add_u32 s5, s5, 0xc2b2ae35
    s_waitcnt vmcnt(0)
    s_barrier
    s_cmp_lg_u32 s30, 0
    s_cbranch_scc1 L_pa_nf
    v_mov_b32 v24, s4
    v_mov_b32 v25, s5
    v_mov_b32 v26, 0
    s_mov_b64 exec, 1
    buffer_store_dwordx2 v[24:25], v26, s[48:51], s54 offen offset:0 sc1
    s_mov_b64 exec, -1
L_pa_nf:
    s_mov_b32 s36, 0
    s_sub_u32 s46, s36, s59
    s_sub_u32 s38, s46, s24
    s_and_b32 s38, s38, 3
    s_cmp_le_u32 s38, 2
    s_cselect_b32 s39, -1, 0
    s_cmp_eq_u32 s38, 0
    s_cselect_b32 s39, 2, s39
    s_cmp_lt_u32 s46, s24
    s_cselect_b32 s39, 0, s39
    s_sub_u32 s38, s46, s38
    s_cmp_ge_i32 s38, s55
    s_cselect_b32 s39, 0, s39
    s_add_u32 s37, s46, s39
    s_add_u32 s37, s37, s53
    s_mul_i32 s45, s37, 458752
    s_lshl_b32 s38, s37, 14
    s_add_u32 s46, s38, s29
    s_add_u32 s58, s38, s28
    s_add_u32 s44, s33, s31
    s_add_u32 m0, s44, 0
    s_nop 0
    buffer_load_dwordx4 v8, s[8:11], s45 offen lds
    s_add_u32 m0, s44, 4096
    s_add_u32 s45, s45, 114688
    buffer_load_dwordx4 v8, s[8:11], s45 offen lds
    s_add_u32 m0, s44, 8192
    s_add_u32 s45, s45, 114688
    buffer_load_dwordx4 v8, s[8:11], s45 offen lds
    s_add_u32 m0, s44, 12288
    s_add_u32 s45, s45, 114688
    buffer_load_dwordx4 v8, s[8:11], s45 offen lds
    s_add_u32 s33, s33, 49152
    s_cmp_eq_u32 s33, 147456
    s_cselect_b32 s33, 0, s33
    s_add_u32 s36, s36, 1
    s_sub_u32 s46, s36, s59
    s_sub_u32 s38, s46, s24
    s_and_b32 s38, s38, 3
    s_cmp_le_u32 s38, 2
    s_cselect_b32 s39, -1, 0
    s_cmp_eq_u32 s38, 0
    s_cselect_b32 s39, 2, s39
    s_cmp_lt_u32 s46, s24
    s_cselect_b32 s39, 0, s39
    s_sub_u32 s38, s46, s38
    s_cmp_ge_i32 s38, s55
    s_cselect_b32 s39, 0, s39
    s_add_u32 s37, s46, s39
    s_add_u32 s37, s37, s53
    s_mul_i32 s45, s37, 458752
    s_lshl_b32 s38, s37, 14
    s_add_u32 s46, s38, s29
    s_add_u32 s58, s38, s28
    s_add_u32 s44, s33, s31
    s_add_u32 m0, s44, 0
    s_nop 0
    buffer_load_dwordx4 v8, s[8:11], s45 offen lds
    s_add_u32 m0, s44, 4096
    s_add_u32 s45, s45, 114688
    buffer_load_dwordx4 v8, s[8:11], s45 offen lds
    s_add_u32 m0, s44, 8192
    s_add_u32 s45, s45, 114688
    buffer_load_dwordx4 v8, s[8:11], s45 offen lds
    s_add_u32 m0, s44, 12288
    s_add_u32 s45, s45, 114688
    buffer_load_dwordx4 v8, s[8:11], s45 offen lds
    s_add_u32 s33, s33, 49152
    s_cmp_eq_u32 s33, 147456
    s_cselect_b32 s33, 0, s33
    s_add_u32 s36, s36, 1
    buffer_load_dwordx2 v[10:11], v13, s[48:51], s34 offen sc1
    s_mov_b32 s36, 0
    s_mov_b32 s33, 0
    s_sub_u32 s46, s36, s59
    s_sub_u32 s38, s46, s24
    s_and_b32 s38, s38, 3
    s_cmp_le_u32 s38, 2
    s_cselect_b32 s39, -1, 0
    s_cmp_eq_u32 s38, 0
    s_cselect_b32 s39, 2, s39
    s_cmp_lt_u32 s46, s24
    s_cselect_b32 s39, 0, s39
    s_sub_u32 s38, s46, s38
    s_cmp_ge_i32 s38, s55
    s_cselect_b32 s39, 0, s39
    s_add_u32 s37, s46, s39
    s_add_u32 s37, s37, s53
    s_mul_i32 s45, s37, 458752
    s_lshl_b32 s38, s37, 14
    s_add_u32 s46, s38, s29
    s_add_u32 s58, s38, s28
    s_waitcnt vmcnt(0)
    s_mov_b32 s35, 131072
    s_branch L_fwq_chk
L_fwq_rd:
    buffer_load_dwordx2 v[10:11], v13, s[48:51], s34 offen sc1
    s_waitcnt vmcnt(0)
L_fwq_chk:
    v_cmp_ne_u64 vcc, s[4:5], v[10:11]
    s_cbranch_vccz L_fwq_ok
    s_sleep 2
    s_sub_u32 s35, s35, 1
    s_cmp_lg_u32 s35, 0
    s_cbranch_scc1 L_fwq_rd
L_fwq_ok:
    s_add_u32 s3, s33, s32
    s_add_u32 m0, s3, 16384
    s_nop 0
    buffer_load_dwordx4 v9, s[12:15], s46 offen offset:0 lds
    buffer_load_dwordx4 v9, s[12:15], s46 offen offset:1024 lds
    buffer_load_dwordx4 v9, s[12:15], s46 offen offset:2048 lds
    buffer_load_dwordx4 v9, s[12:15], s46 offen offset:3072 lds
    s_add_u32 s3, s33, s32
    s_add_u32 m0, s3, 32768
    s_nop 0
    buffer_load_dwordx4 v9, s[12:15], s58 offen offset:0 lds
    buffer_load_dwordx4 v9, s[12:15], s58 offen offset:1024 lds
    buffer_load_dwordx4 v9, s[12:15], s58 offen offset:2048 lds
    buffer_load_dwordx4 v9, s[12:15], s58 offen offset:3072 lds
    s_add_u32 s33, s33, 49152
    s_cmp_eq_u32 s33, 147456
    s_cselect_b32 s33, 0, s33
    s_add_u32 s36, s36, 1
    s_sub_u32 s46, s36, s59
    s_sub_u32 s38, s46, s24
    s_and_b32 s38, s38, 3
    s_cmp_le_u32 s38, 2
    s_cselect_b32 s39, -1, 0
    s_cmp_eq_u32 s38, 0
    s_cselect_b32 s39, 2, s39
    s_cmp_lt_u32 s46, s24
    s_cselect_b32 s39, 0, s39
    s_sub_u32 s38, s46, s38
    s_cmp_ge_i32 s38, s55
    s_cselect_b32 s39, 0, s39
    s_add_u32 s37, s46, s39
    s_add_u32 s37, s37, s53
    s_mul_i32 s45, s37, 458752
    s_lshl_b32 s38, s37, 14
    s_add_u32 s46, s38, s29
    s_add_u32 s58, s38, s28
    s_add_u32 s3, s33, s32
    s_add_u32 m0, s3, 16384
    s_nop 0
    buffer_load_dwordx4 v9, s[12:15], s46 offen offset:0 lds
    buffer_load_dwordx4 v9, s[12:15], s46 offen offset:1024 lds
    buffer_load_dwordx4 v9, s[12:15], s46 offen offset:2048 lds
    buffer_load_dwordx4 v9, s[12:15], s46 offen offset:3072 lds
    s_add_u32 s3, s33, s32
    s_add_u32 m0, s3, 32768
    s_nop 0
    buffer_load_dwordx4 v9, s[12:15], s58 offen offset:0 lds
    buffer_load_dwordx4 v9, s[12:15], s58 offen offset:1024 lds
    buffer_load_dwordx4 v9, s[12:15], s58 offen offset:2048 lds
    buffer_load_dwordx4 v9, s[12:15], s58 offen offset:3072 lds
    s_add_u32 s33, s33, 49152
    s_cmp_eq_u32 s33, 147456
    s_cselect_b32 s33, 0, s33
    s_add_u32 s36, s36, 1
    s_and_b32 s34, s22, 6
    s_mul_i32 s34, s34, 3584
    s_add_u32 s34, s34, 64
    v_min_u32 v13, 55, v2
    v_lshlrev_b32 v13, 7, v13
    s_sub_u32 s46, s36, s59
    s_sub_u32 s38, s46, s24
    s_and_b32 s38, s38, 3
    s_cmp_le_u32 s38, 2
    s_cselect_b32 s39, -1, 0
    s_cmp_eq_u32 s38, 0
    s_cselect_b32 s39, 2, s39
    s_cmp_lt_u32 s46, s24
    s_cselect_b32 s39, 0, s39
    s_sub_u32 s38, s46, s38
    s_cmp_ge_i32 s38, s55
    s_cselect_b32 s39, 0, s39
    s_add_u32 s37, s46, s39
    s_add_u32 s37, s37, s53
    s_mul_i32 s45, s37, 458752
    s_lshl_b32 s38, s37, 14
    s_add_u32 s46, s38, s29
    s_add_u32 s58, s38, s28
    s_waitcnt vmcnt(8)
    s_barrier
    s_add_u32 s3, s33, s32
    s_add_u32 m0, s3, 16384
    s_nop 0
    buffer_load_dwordx4 v9, s[12:15], s46 offen offset:0 lds
    buffer_load_dwordx4 v9, s[12:15], s46 offen offset:1024 lds
    buffer_load_dwordx4 v9, s[12:15], s46 offen offset:2048 lds
    buffer_load_dwordx4 v9, s[12:15], s46 offen offset:3072 lds
    s_add_u32 s3, s33, s32
    s_add_u32 m0, s3, 32768
    s_nop 0
    buffer_load_dwordx4 v9, s[12:15], s58 offen offset:0 lds
    buffer_load_dwordx4 v9, s[12:15], s58 offen offset:1024 lds
    buffer_load_dwordx4 v9, s[12:15], s58 offen offset:2048 lds
    buffer_load_dwordx4 v9, s[12:15], s58 offen offset:3072 lds
    s_add_u32 s44, s33, s31
    s_add_u32 m0, s44, 0
    s_nop 0
    buffer_load_dwordx4 v8, s[8:11], s45 offen lds
    s_add_u32 m0, s44, 4096
    s_add_u32 s45, s45, 114688
    buffer_load_dwordx4 v8, s[8:11], s45 offen lds
    s_add_u32 m0, s44, 8192
    s_add_u32 s45, s45, 114688
    buffer_load_dwordx4 v8, s[8:11], s45 offen lds
    s_add_u32 m0, s44, 12288
    s_add_u32 s45, s45, 114688
    buffer_load_dwordx4 v8, s[8:11], s45 offen lds
    s_add_u32 s33, s33, 49152
    s_cmp_eq_u32 s33, 147456
    s_cselect_b32 s33, 0, s33
    s_add_u32 s36, s36, 1
    s_sub_u32 s46, s36, s59
    s_sub_u32 s38, s46, s24
    s_and_b32 s38, s38, 3
    s_cmp_le_u32 s38, 2
    s_cselect_b32 s39, -1, 0
    s_cmp_eq_u32 s38, 0
    s_cselect_b32 s39, 2, s39
    s_cmp_lt_u32 s46, s24
    s_cselect_b32 s39, 0, s39
    s_sub_u32 s38, s46, s38
    s_cmp_ge_i32 s38, s55
    s_cselect_b32 s39, 0, s39
    s_add_u32 s37, s46, s39
    s_add_u32 s37, s37, s53
    s_mul_i32 s45, s37, 458752
    s_lshl_b32 s38, s37, 14
    s_add_u32 s46, s38, s29
    s_add_u32 s58, s38, s28
    s_waitcnt vmcnt(12)
    s_barrier
    s_add_u32 s3, s33, s32
    s_add_u32 m0, s3, 16384
    s_nop 0
    buffer_load_dwordx4 v9, s[12:15], s46 offen offset:0 lds
    buffer_load_dwordx4 v9, s[12:15], s46 offen offset:1024 lds
    buffer_load_dwordx4 v9, s[12:15], s46 offen offset:2048 lds
    buffer_load_dwordx4 v9, s[12:15], s46 offen offset:3072 lds
    s_add_u32 s3, s33, s32
    s_add_u32 m0, s3, 32768
    s_nop 0
    buffer_load_dwordx4 v9, s[12:15], s58 offen offset:0 lds
    buffer_load_dwordx4 v9, s[12:15], s58 offen offset:1024 lds
    buffer_load_dwordx4 v9, s[12:15], s58 offen offset:2048 lds
    buffer_load_dwordx4 v9, s[12:15], s58 offen offset:3072 lds
    s_add_u32 s44, s33, s31
    s_add_u32 m0, s44, 0
    s_nop 0
    buffer_load_dwordx4 v8, s[8:11], s45 offen lds
    s_add_u32 m0, s44, 4096
    s_add_u32 s45, s45, 114688
    buffer_load_dwordx4 v8, s[8:11], s45 offen lds
    s_add_u32 m0, s44, 8192
    s_add_u32 s45, s45, 114688
    buffer_load_dwordx4 v8, s[8:11], s45 offen lds
    s_add_u32 m0, s44, 12288
    s_add_u32 s45, s45, 114688
    buffer_load_dwordx4 v8, s[8:11], s45 offen lds
    s_add_u32 s33, s33, 49152
    s_cmp_eq_u32 s33, 147456
    s_cselect_b32 s33, 0, s33
    s_add_u32 s36, s36, 1
    s_and_b32 s38, s20, 1
    s_mul_i32 s38, s38, 14
    s_lshr_b32 s35, s23, 1
    s_add_u32 s38, s38, s35
    s_cmp_lt_u32 s38, 11
    s_cselect_b32 s35, 14, 28
    s_add_u32 s38, s38, s35
    s_lshl_b32 s39, s30, 1
    s_and_b32 s47, s22, 6
    s_and_b32 s35, s23, 1
    s_or_b32 s47, s47, s35
    s_lshl_b32 s26, s47, 3
    s_add_u32 s26, s26, s39
    s_mul_i32 s27, s26, 229376
    s_lshl_b32 s35, s38, 8
    s_add_u32 s27, s27, s35
    s_lshr_b32 s26, s26, 1
    s_mul_i32 s26, s26, 7168
    s_lshl_b32 s35, s38, 7
    s_add_u32 s26, s26, s35
    buffer_load_dwordx4 v[160:163], v21, s[40:43], s27 offen offset:0
    buffer_load_dwordx4 v[164:167], v21, s[40:43], s27 offen offset:128
    buffer_load_dwordx2 v[192:193], v22, s[76:79], s26 offen offset:0
    buffer_load_dwordx2 v[196:197], v22, s[16:19], s26 offen offset:0
    buffer_load_dwordx2 v[194:195], v22, s[76:79], s26 offen offset:64
    buffer_load_dwordx2 v[198:199], v22, s[16:19], s26 offen offset:64
    s_add_u32 s27, s27, 114688
    buffer_load_dwordx4 v[168:171], v21, s[40:43], s27 offen offset:0
    buffer_load_dwordx4 v[172:175], v21, s[40:43], s27 offen offset:128
    s_add_u32 s27, s27, 114688
    buffer_load_dwordx4 v[176:179], v21, s[40:43], s27 offen offset:0
    buffer_load_dwordx4 v[180:183], v21, s[40:43], s27 offen offset:128
    s_add_u32 s27, s27, 114688
    buffer_load_dwordx4 v[184:187], v21, s[40:43], s27 offen offset:0
    buffer_load_dwordx4 v[188:191], v21, s[40:43], s27 offen offset:128
    s_mul_i32 s47, s47, 56
    s_add_u32 s47, s47, s38
    s_lshl_b32 s47, s47, 14
    s_lshl_b32 s39, s39, 10
    s_add_u32 s47, s47, s39
    s_sub_u32 s46, s36, s59
    s_sub_u32 s38, s46, s24
    s_and_b32 s38, s38, 3
    s_cmp_le_u32 s38, 2
    s_cselect_b32 s39, -1, 0
    s_cmp_eq_u32 s38, 0
    s_cselect_b32 s39, 2, s39
    s_cmp_lt_u32 s46, s24
    s_cselect_b32 s39, 0, s39
    s_sub_u32 s38, s46, s38
    s_cmp_ge_i32 s38, s55
    s_cselect_b32 s39, 0, s39
    s_add_u32 s37, s46, s39
    s_add_u32 s37, s37, s53
    s_mul_i32 s45, s37, 458752
    s_lshl_b32 s38, s37, 14
    s_add_u32 s46, s38, s29
    s_add_u32 s58, s38, s28
    s_waitcnt vmcnt(24)
    s_barrier
    s_add_u32 s3, s33, s32
    s_add_u32 m0, s3, 16384
    s_nop 0
    buffer_load_dwordx4 v9, s[12:15], s46 offen offset:0 lds
    buffer_load_dwordx4 v9, s[12:15], s46 offen offset:1024 lds
    buffer_load_dwordx4 v9, s[12:15], s46 offen offset:2048 lds
    buffer_load_dwordx4 v9, s[12:15], s46 offen offset:3072 lds
    s_add_u32 s3, s33, s32
    s_add_u32 m0, s3, 32768
    s_nop 0
    buffer_load_dwordx4 v9, s[12:15], s58 offen offset:0 lds
    buffer_load_dwordx4 v9, s[12:15], s58 offen offset:1024 lds
    buffer_load_dwordx4 v9, s[12:15], s58 offen offset:2048 lds
    buffer_load_dwordx4 v9, s[12:15], s58 offen offset:3072 lds
    s_add_u32 s44, s33, s31
    s_add_u32 m0, s44, 0
    s_nop 0
    buffer_load_dwordx4 v8, s[8:11], s45 offen lds
    s_add_u32 m0, s44, 4096
    s_add_u32 s45, s45, 114688
    buffer_load_dwordx4 v8, s[8:11], s45 offen lds
    s_add_u32 m0, s44, 8192
    s_add_u32 s45, s45, 114688
    buffer_load_dwordx4 v8, s[8:11], s45 offen lds
    s_add_u32 m0, s44, 12288
    s_add_u32 s45, s45, 114688
    buffer_load_dwordx4 v8, s[8:11], s45 offen lds
    s_add_u32 s33, s33, 49152
    s_cmp_eq_u32 s33, 147456
    s_cselect_b32 s33, 0, s33
    s_add_u32 s36, s36, 1
    s_sub_u32 s46, s36, s59
    s_sub_u32 s38, s46, s24
    s_and_b32 s38, s38, 3
    s_cmp_le_u32 s38, 2
    s_cselect_b32 s39, -1, 0
    s_cmp_eq_u32 s38, 0
    s_cselect_b32 s39, 2, s39
    s_cmp_lt_u32 s46, s24
    s_cselect_b32 s39, 0, s39
    s_sub_u32 s38, s46, s38
    s_cmp_ge_i32 s38, s55
    s_cselect_b32 s39, 0, s39
    s_add_u32 s37, s46, s39
    s_add_u32 s37, s37, s53
    s_mul_i32 s45, s37, 458752
    s_lshl_b32 s38, s37, 14
    s_add_u32 s46, s38, s29
    s_add_u32 s58, s38, s28
    s_waitcnt vmcnt(24)
    s_barrier
    s_add_u32 s3, s33, s32
    s_add_u32 m0, s3, 16384
    s_nop 0
    buffer_load_dwordx4 v9, s[12:15], s46 offen offset:0 lds
    buffer_load_dwordx4 v9, s[12:15], s46 offen offset:1024 lds
    buffer_load_dwordx4 v9, s[12:15], s46 offen offset:2048 lds
    buffer_load_dwordx4 v9, s[12:15], s46 offen offset:3072 lds
    s_add_u32 s3, s33, s32
    s_add_u32 m0, s3, 32768
    s_nop 0
    buffer_load_dwordx4 v9, s[12:15], s58 offen offset:0 lds
    buffer_load_dwordx4 v9, s[12:15], s58 offen offset:1024 lds
    buffer_load_dwordx4 v9, s[12:15], s58 offen offset:2048 lds
    buffer_load_dwordx4 v9, s[12:15], s58 offen offset:3072 lds
    s_add_u32 s44, s33, s31
    s_add_u32 m0, s44, 0
    s_nop 0
    buffer_load_dwordx4 v8, s[8:11], s45 offen lds
    s_add_u32 m0, s44, 4096
    s_add_u32 s45, s45, 114688
    buffer_load_dwordx4 v8, s[8:11], s45 offen lds
    s_add_u32 m0, s44, 8192
    s_add_u32 s45, s45, 114688
    buffer_load_dwordx4 v8, s[8:11], s45 offen lds
    s_add_u32 m0, s44, 12288
    s_add_u32 s45, s45, 114688
    buffer_load_dwordx4 v8, s[8:11], s45 offen lds
    s_add_u32 s33, s33, 49152
    s_cmp_eq_u32 s33, 147456
    s_cselect_b32 s33, 0, s33
    s_add_u32 s36, s36, 1
    s_waitcnt vmcnt(24)
    v_lshlrev_b32 v200, 16, v192
    v_and_b32 v201, 0xffff0000, v192
    v_lshlrev_b32 v208, 16, v196
    v_and_b32 v209, 0xffff0000, v196
    v_lshlrev_b32 v202, 16, v193
    v_and_b32 v203, 0xffff0000, v193
    v_lshlrev_b32 v210, 16, v197
    v_and_b32 v211, 0xffff0000, v197
    v_lshlrev_b32 v204, 16, v194
    v_and_b32 v205, 0xffff0000, v194
    v_lshlrev_b32 v212, 16, v198
    v_and_b32 v213, 0xffff0000, v198
    v_lshlrev_b32 v206, 16, v195
    v_and_b32 v207, 0xffff0000, v195
    v_lshlrev_b32 v214, 16, v199
    v_and_b32 v215, 0xffff0000, v199
    v_cvt_f32_i32 v160, v160
    v_cvt_f32_i32 v161, v161
    v_cvt_f32_i32 v162, v162
    v_cvt_f32_i32 v163, v163
    v_cvt_f32_i32 v164, v164
    v_cvt_f32_i32 v165, v165
    v_cvt_f32_i32 v166, v166
    v_cvt_f32_i32 v167, v167
    v_cvt_pk_bf16_f32 v160, 0, v160
    v_cvt_pk_bf16_f32 v161, 0, v161
    v_cvt_pk_bf16_f32 v162, 0, v162
    v_cvt_pk_bf16_f32 v163, 0, v163
    v_cvt_pk_bf16_f32 v164, 0, v164
    v_cvt_pk_bf16_f32 v165, 0, v165
    v_cvt_pk_bf16_f32 v166, 0, v166
    v_cvt_pk_bf16_f32 v167, 0, v167
    v_sub_f32 v160, v160, v208
    v_sub_f32 v161, v161, v209
    v_sub_f32 v162, v162, v210
    v_sub_f32 v163, v163, v211
    v_sub_f32 v164, v164, v212
    v_sub_f32 v165, v165, v213
    v_sub_f32 v166, v166, v214
    v_sub_f32 v167, v167, v215
    v_cvt_pk_bf16_f32 v160, 0, v160
    v_cvt_pk_bf16_f32 v161, 0, v161
    v_cvt_pk_bf16_f32 v162, 0, v162
    v_cvt_pk_bf16_f32 v163, 0, v163
    v_cvt_pk_bf16_f32 v164, 0, v164
    v_cvt_pk_bf16_f32 v165, 0, v165
    v_cvt_pk_bf16_f32 v166, 0, v166
    v_cvt_pk_bf16_f32 v167, 0, v167
    v_mul_f32 v160, v160, v200
    v_mul_f32 v161, v161, v201
    v_mul_f32 v162, v162, v202
    v_mul_f32 v163, v163, v203
    v_mul_f32 v164, v164, v204
    v_mul_f32 v165, v165, v205
    v_mul_f32 v166, v166, v206
    v_mul_f32 v167, v167, v207
    v_cvt_pk_bf16_f32 v160, v160, v161
    v_cvt_pk_bf16_f32 v161, v162, v163
    v_cvt_pk_bf16_f32 v162, v164, v165
    v_cvt_pk_bf16_f32 v163, v166, v167
    buffer_store_dwordx4 v[160:163], v1, s[12:15], s47 offen offset:0 sc1
    s_sub_u32 s46, s36, s59
    s_sub_u32 s38, s46, s24
    s_and_b32 s38, s38, 3
    s_cmp_le_u32 s38, 2
    s_cselect_b32 s39, -1, 0
    s_cmp_eq_u32 s38, 0
    s_cselect_b32 s39, 2, s39
    s_cmp_lt_u32 s46, s24
    s_cselect_b32 s39, 0, s39
    s_sub_u32 s38, s46, s38
    s_cmp_ge_i32 s38, s55
    s_cselect_b32 s39, 0, s39
    s_add_u32 s37, s46, s39
    s_add_u32 s37, s37, s53
    s_mul_i32 s45, s37, 458752
    s_lshl_b32 s38, s37, 14
    s_add_u32 s46, s38, s29
    s_add_u32 s58, s38, s28
    s_waitcnt vmcnt(13)
    s_barrier
    s_add_u32 s3, s33, s32
    s_add_u32 m0, s3, 16384
    s_nop 0
    buffer_load_dwordx4 v9, s[12:15], s46 offen offset:0 lds
    buffer_load_dwordx4 v9, s[12:15], s46 offen offset:1024 lds
    buffer_load_dwordx4 v9, s[12:15], s46 offen offset:2048 lds
    buffer_load_dwordx4 v9, s[12:15], s46 offen offset:3072 lds
    s_add_u32 s3, s33, s32
    s_add_u32 m0, s3, 32768
    s_nop 0
    buffer_load_dwordx4 v9, s[12:15], s58 offen offset:0 lds
    buffer_load_dwordx4 v9, s[12:15], s58 offen offset:1024 lds
    buffer_load_dwordx4 v9, s[12:15], s58 offen offset:2048 lds
    buffer_load_dwordx4 v9, s[12:15], s58 offen offset:3072 lds
    s_add_u32 s44, s33, s31
    s_add_u32 m0, s44, 0
    s_nop 0
    buffer_load_dwordx4 v8, s[8:11], s45 offen lds
    s_add_u32 m0, s44, 4096
    s_add_u32 s45, s45, 114688
    buffer_load_dwordx4 v8, s[8:11], s45 offen lds
    s_add_u32 m0, s44, 8192
    s_add_u32 s45, s45, 114688
    buffer_load_dwordx4 v8, s[8:11], s45 offen lds
    s_add_u32 m0, s44, 12288
    s_add_u32 s45, s45, 114688
    buffer_load_dwordx4 v8, s[8:11], s45 offen lds
    s_add_u32 s33, s33, 49152
    s_cmp_eq_u32 s33, 147456
    s_cselect_b32 s33, 0, s33
    s_add_u32 s36, s36, 1
    s_waitcnt vmcnt(37)
    v_cvt_f32_i32 v168, v168
    v_cvt_f32_i32 v169, v169
    v_cvt_f32_i32 v170, v170
    v_cvt_f32_i32 v171, v171
    v_cvt_f32_i32 v172, v172
    v_cvt_f32_i32 v173, v173
    v_cvt_f32_i32 v174, v174
    v_cvt_f32_i32 v175, v175
    v_cvt_pk_bf16_f32 v168, 0, v168
    v_cvt_pk_bf16_f32 v169, 0, v169
    v_cvt_pk_bf16_f32 v170, 0, v170
    v_cvt_pk_bf16_f32 v171, 0, v171
    v_cvt_pk_bf16_f32 v172, 0, v172
    v_cvt_pk_bf16_f32 v173, 0, v173
    v_cvt_pk_bf16_f32 v174, 0, v174
    v_cvt_pk_bf16_f32 v175, 0, v175
    v_sub_f32 v168, v168, v208
    v_sub_f32 v169, v169, v209
    v_sub_f32 v170, v170, v210
    v_sub_f32 v171, v171, v211
    v_sub_f32 v172, v172, v212
    v_sub_f32 v173, v173, v213
    v_sub_f32 v174, v174, v214
    v_sub_f32 v175, v175, v215
    v_cvt_pk_bf16_f32 v168, 0, v168
    v_cvt_pk_bf16_f32 v169, 0, v169
    v_cvt_pk_bf16_f32 v170, 0, v170
    v_cvt_pk_bf16_f32 v171, 0, v171
    v_cvt_pk_bf16_f32 v172, 0, v172
    v_cvt_pk_bf16_f32 v173, 0, v173
    v_cvt_pk_bf16_f32 v174, 0, v174
    v_cvt_pk_bf16_f32 v175, 0, v175
    v_mul_f32 v168, v168, v200
    v_mul_f32 v169, v169, v201
    v_mul_f32 v170, v170, v202
    v_mul_f32 v171, v171, v203
    v_mul_f32 v172, v172, v204
    v_mul_f32 v173, v173, v205
    v_mul_f32 v174, v174, v206
    v_mul_f32 v175, v175, v207
    v_cvt_pk_bf16_f32 v168, v168, v169
    v_cvt_pk_bf16_f32 v169, v170, v171
    v_cvt_pk_bf16_f32 v170, v172, v173
    v_cvt_pk_bf16_f32 v171, v174, v175
    buffer_store_dwordx4 v[168:171], v1, s[12:15], s47 offen offset:128 sc1
    s_sub_u32 s46, s36, s59
    s_sub_u32 s38, s46, s24
    s_and_b32 s38, s38, 3
    s_cmp_le_u32 s38, 2
    s_cselect_b32 s39, -1, 0
    s_cmp_eq_u32 s38, 0
    s_cselect_b32 s39, 2, s39
    s_cmp_lt_u32 s46, s24
    s_cselect_b32 s39, 0, s39
    s_sub_u32 s38, s46, s38
    s_cmp_ge_i32 s38, s55
    s_cselect_b32 s39, 0, s39
    s_add_u32 s37, s46, s39
    s_add_u32 s37, s37, s53
    s_mul_i32 s45, s37, 458752
    s_lshl_b32 s38, s37, 14
    s_add_u32 s46, s38, s29
    s_add_u32 s58, s38, s28
    s_waitcnt vmcnt(14)
    s_barrier
    s_add_u32 s3, s33, s32
    s_add_u32 m0, s3, 16384
    s_nop 0
    buffer_load_dwordx4 v9, s[12:15], s46 offen offset:0 lds
    buffer_load_dwordx4 v9, s[12:15], s46 offen offset:1024 lds
    buffer_load_dwordx4 v9, s[12:15], s46 offen offset:2048 lds
    buffer_load_dwordx4 v9, s[12:15], s46 offen offset:3072 lds
    s_add_u32 s3, s33, s32
    s_add_u32 m0, s3, 32768
    s_nop 0
    buffer_load_dwordx4 v9, s[12:15], s58 offen offset:0 lds
    buffer_load_dwordx4 v9, s[12:15], s58 offen offset:1024 lds
    buffer_load_dwordx4 v9, s[12:15], s58 offen offset:2048 lds
    buffer_load_dwordx4 v9, s[12:15], s58 offen offset:3072 lds
    s_add_u32 s44, s33, s31
    s_add_u32 m0, s44, 0
    s_nop 0
    buffer_load_dwordx4 v8, s[8:11], s45 offen lds
    s_add_u32 m0, s44, 4096
    s_add_u32 s45, s45, 114688
    buffer_load_dwordx4 v8, s[8:11], s45 offen lds
    s_add_u32 m0, s44, 8192
    s_add_u32 s45, s45, 114688
    buffer_load_dwordx4 v8, s[8:11], s45 offen lds
    s_add_u32 m0, s44, 12288
    s_add_u32 s45, s45, 114688
    buffer_load_dwordx4 v8, s[8:11], s45 offen lds
    s_add_u32 s33, s33, 49152
    s_cmp_eq_u32 s33, 147456
    s_cselect_b32 s33, 0, s33
    s_add_u32 s36, s36, 1
    s_waitcnt vmcnt(50)
    v_cvt_f32_i32 v176, v176
    v_cvt_f32_i32 v177, v177
    v_cvt_f32_i32 v178, v178
    v_cvt_f32_i32 v179, v179
    v_cvt_f32_i32 v180, v180
    v_cvt_f32_i32 v181, v181
    v_cvt_f32_i32 v182, v182
    v_cvt_f32_i32 v183, v183
    v_cvt_pk_bf16_f32 v176, 0, v176
    v_cvt_pk_bf16_f32 v177, 0, v177
    v_cvt_pk_bf16_f32 v178, 0, v178
    v_cvt_pk_bf16_f32 v179, 0, v179
    v_cvt_pk_bf16_f32 v180, 0, v180
    v_cvt_pk_bf16_f32 v181, 0, v181
    v_cvt_pk_bf16_f32 v182, 0, v182
    v_cvt_pk_bf16_f32 v183, 0, v183
    v_sub_f32 v176, v176, v208
    v_sub_f32 v177, v177, v209
    v_sub_f32 v178, v178, v210
    v_sub_f32 v179, v179, v211
    v_sub_f32 v180, v180, v212
    v_sub_f32 v181, v181, v213
    v_sub_f32 v182, v182, v214
    v_sub_f32 v183, v183, v215
    v_cvt_pk_bf16_f32 v176, 0, v176
    v_cvt_pk_bf16_f32 v177, 0, v177
    v_cvt_pk_bf16_f32 v178, 0, v178
    v_cvt_pk_bf16_f32 v179, 0, v179
    v_cvt_pk_bf16_f32 v180, 0, v180
    v_cvt_pk_bf16_f32 v181, 0, v181
    v_cvt_pk_bf16_f32 v182, 0, v182
    v_cvt_pk_bf16_f32 v183, 0, v183
    v_mul_f32 v176, v176, v200
    v_mul_f32 v177, v177, v201
    v_mul_f32 v178, v178, v202
    v_mul_f32 v179, v179, v203
    v_mul_f32 v180, v180, v204
    v_mul_f32 v181, v181, v205
    v_mul_f32 v182, v182, v206
    v_mul_f32 v183, v183, v207
    v_cvt_pk_bf16_f32 v176, v176, v177
    v_cvt_pk_bf16_f32 v177, v178, v179
    v_cvt_pk_bf16_f32 v178, v180, v181
    v_cvt_pk_bf16_f32 v179, v182, v183
    buffer_store_dwordx4 v[176:179], v1, s[12:15], s47 offen offset:1024 sc1
    s_sub_u32 s46, s36, s59
    s_sub_u32 s38, s46, s24
    s_and_b32 s38, s38, 3
    s_cmp_le_u32 s38, 2
    s_cselect_b32 s39, -1, 0
    s_cmp_eq_u32 s38, 0
    s_cselect_b32 s39, 2, s39
    s_cmp_lt_u32 s46, s24
    s_cselect_b32 s39, 0, s39
    s_sub_u32 s38, s46, s38
    s_cmp_ge_i32 s38, s55
    s_cselect_b32 s39, 0, s39
    s_add_u32 s37, s46, s39
    s_add_u32 s37, s37, s53
    s_mul_i32 s45, s37, 458752
    s_lshl_b32 s38, s37, 14
    s_add_u32 s46, s38, s29
    s_add_u32 s58, s38, s28
    s_waitcnt vmcnt(14)
    s_barrier
    s_add_u32 s3, s33, s32
    s_add_u32 m0, s3, 16384
    s_nop 0
    buffer_load_dwordx4 v9, s[12:15], s46 offen offset:0 lds
    buffer_load_dwordx4 v9, s[12:15], s46 offen offset:1024 lds
    buffer_load_dwordx4 v9, s[12:15], s46 offen offset:2048 lds
    buffer_load_dwordx4 v9, s[12:15], s46 offen offset:3072 lds
    s_add_u32 s3, s33, s32
    s_add_u32 m0, s3, 32768
    s_nop 0
    buffer_load_dwordx4 v9, s[12:15], s58 offen offset:0 lds
    buffer_load_dwordx4 v9, s[12:15], s58 offen offset:1024 lds
    buffer_load_dwordx4 v9, s[12:15], s58 offen offset:2048 lds
    buffer_load_dwordx4 v9, s[12:15], s58 offen offset:3072 lds
    s_add_u32 s44, s33, s31
    s_add_u32 m0, s44, 0
    s_nop 0
    buffer_load_dwordx4 v8, s[8:11], s45 offen lds
    s_add_u32 m0, s44, 4096
    s_add_u32 s45, s45, 114688
    buffer_load_dwordx4 v8, s[8:11], s45 offen lds
    s_add_u32 m0, s44, 8192
    s_add_u32 s45, s45, 114688
    buffer_load_dwordx4 v8, s[8:11], s45 offen lds
    s_add_u32 m0, s44, 12288
    s_add_u32 s45, s45, 114688
    buffer_load_dwordx4 v8, s[8:11], s45 offen lds
    s_add_u32 s33, s33, 49152
    s_cmp_eq_u32 s33, 147456
    s_cselect_b32 s33, 0, s33
    s_add_u32 s36, s36, 1
    s_waitcnt vmcnt(63)
    v_cvt_f32_i32 v184, v184
    v_cvt_f32_i32 v185, v185
    v_cvt_f32_i32 v186, v186
    v_cvt_f32_i32 v187, v187
    v_cvt_f32_i32 v188, v188
    v_cvt_f32_i32 v189, v189
    v_cvt_f32_i32 v190, v190
    v_cvt_f32_i32 v191, v191
    v_cvt_pk_bf16_f32 v184, 0, v184
    v_cvt_pk_bf16_f32 v185, 0, v185
    v_cvt_pk_bf16_f32 v186, 0, v186
    v_cvt_pk_bf16_f32 v187, 0, v187
    v_cvt_pk_bf16_f32 v188, 0, v188
    v_cvt_pk_bf16_f32 v189, 0, v189
    v_cvt_pk_bf16_f32 v190, 0, v190
    v_cvt_pk_bf16_f32 v191, 0, v191
    v_sub_f32 v184, v184, v208
    v_sub_f32 v185, v185, v209
    v_sub_f32 v186, v186, v210
    v_sub_f32 v187, v187, v211
    v_sub_f32 v188, v188, v212
    v_sub_f32 v189, v189, v213
    v_sub_f32 v190, v190, v214
    v_sub_f32 v191, v191, v215
    v_cvt_pk_bf16_f32 v184, 0, v184
    v_cvt_pk_bf16_f32 v185, 0, v185
    v_cvt_pk_bf16_f32 v186, 0, v186
    v_cvt_pk_bf16_f32 v187, 0, v187
    v_cvt_pk_bf16_f32 v188, 0, v188
    v_cvt_pk_bf16_f32 v189, 0, v189
    v_cvt_pk_bf16_f32 v190, 0, v190
    v_cvt_pk_bf16_f32 v191, 0, v191
    v_mul_f32 v184, v184, v200
    v_mul_f32 v185, v185, v201
    v_mul_f32 v186, v186, v202
    v_mul_f32 v187, v187, v203
    v_mul_f32 v188, v188, v204
    v_mul_f32 v189, v189, v205
    v_mul_f32 v190, v190, v206
    v_mul_f32 v191, v191, v207
    v_cvt_pk_bf16_f32 v184, v184, v185
    v_cvt_pk_bf16_f32 v185, v186, v187
    v_cvt_pk_bf16_f32 v186, v188, v189
    v_cvt_pk_bf16_f32 v187, v190, v191
    buffer_store_dwordx4 v[184:187], v1, s[12:15], s47 offen offset:1152 sc1
    s_sub_u32 s46, s36, s59
    s_sub_u32 s38, s46, s24
    s_and_b32 s38, s38, 3
    s_cmp_le_u32 s38, 2
    s_cselect_b32 s39, -1, 0
    s_cmp_eq_u32 s38, 0
    s_cselect_b32 s39, 2, s39
    s_cmp_lt_u32 s46, s24
    s_cselect_b32 s39, 0, s39
    s_sub_u32 s38, s46, s38
    s_cmp_ge_i32 s38, s55
    s_cselect_b32 s39, 0, s39
    s_add_u32 s37, s46, s39
    s_add_u32 s37, s37, s53
    s_mul_i32 s45, s37, 458752
    s_lshl_b32 s38, s37, 14
    s_add_u32 s46, s38, s29
    s_add_u32 s58, s38, s28
    s_waitcnt vmcnt(14)
    s_barrier
    s_add_u32 s3, s33, s32
    s_add_u32 m0, s3, 16384
    s_nop 0
    buffer_load_dwordx4 v9, s[12:15], s46 offen offset:0 lds
    buffer_load_dwordx4 v9, s[12:15], s46 offen offset:1024 lds
    buffer_load_dwordx4 v9, s[12:15], s46 offen offset:2048 lds
    buffer_load_dwordx4 v9, s[12:15], s46 offen offset:3072 lds
    s_add_u32 s3, s33, s32
    s_add_u32 m0, s3, 32768
    s_nop 0
    buffer_load_dwordx4 v9, s[12:15], s58 offen offset:0 lds
    buffer_load_dwordx4 v9, s[12:15], s58 offen offset:1024 lds
    buffer_load_dwordx4 v9, s[12:15], s58 offen offset:2048 lds
    buffer_load_dwordx4 v9, s[12:15], s58 offen offset:3072 lds
    s_add_u32 s44, s33, s31
    s_add_u32 m0, s44, 0
    s_nop 0
    buffer_load_dwordx4 v8, s[8:11], s45 offen lds
    s_add_u32 m0, s44, 4096
    s_add_u32 s45, s45, 114688
    buffer_load_dwordx4 v8, s[8:11], s45 offen lds
    s_add_u32 m0, s44, 8192
    s_add_u32 s45, s45, 114688
    buffer_load_dwordx4 v8, s[8:11], s45 offen lds
    s_add_u32 m0, s44, 12288
    s_add_u32 s45, s45, 114688
    buffer_load_dwordx4 v8, s[8:11], s45 offen lds
    s_add_u32 s33, s33, 49152
    s_cmp_eq_u32 s33, 147456
    s_cselect_b32 s33, 0, s33
    s_add_u32 s36, s36, 1
    s_sub_u32 s46, s36, s59
    s_sub_u32 s38, s46, s24
    s_and_b32 s38, s38, 3
    s_cmp_le_u32 s38, 2
    s_cselect_b32 s39, -1, 0
    s_cmp_eq_u32 s38, 0
    s_cselect_b32 s39, 2, s39
    s_cmp_lt_u32 s46, s24
    s_cselect_b32 s39, 0, s39
    s_sub_u32 s38, s46, s38
    s_cmp_ge_i32 s38, s55
    s_cselect_b32 s39, 0, s39
    s_add_u32 s37, s46, s39
    s_add_u32 s37, s37, s53
    s_mul_i32 s45, s37, 458752
    s_lshl_b32 s38, s37, 14
    s_add_u32 s46, s38, s29
    s_add_u32 s58, s38, s28
    s_waitcnt vmcnt(12)
    s_barrier
    s_cmp_lg_u32 s30, 0
    s_cbranch_scc1 L_pa_nf2
    v_mov_b32 v24, s4
    v_mov_b32 v25, s5
    v_mov_b32 v26, 0
    s_mov_b64 exec, 1
    buffer_store_dwordx2 v[24:25], v26, s[48:51], s54 offen offset:64 sc1
    s_mov_b64 exec, -1
L_pa_nf2:
    s_add_u32 s3, s33, s32
    s_add_u32 m0, s3, 16384
    s_nop 0
    buffer_load_dwordx4 v9, s[12:15], s46 offen offset:0 lds
    buffer_load_dwordx4 v9, s[12:15], s46 offen offset:1024 lds
    buffer_load_dwordx4 v9, s[12:15], s46 offen offset:2048 lds
    buffer_load_dwordx4 v9, s[12:15], s46 offen offset:3072 lds
    s_add_u32 s3, s33, s32
    s_add_u32 m0, s3, 32768
    s_nop 0
    buffer_load_dwordx4 v9, s[12:15], s58 offen offset:0 lds
    buffer_load_dwordx4 v9, s[12:15], s58 offen offset:1024 lds
    buffer_load_dwordx4 v9, s[12:15], s58 offen offset:2048 lds
    buffer_load_dwordx4 v9, s[12:15], s58 offen offset:3072 lds
    s_add_u32 s44, s33, s31
    s_add_u32 m0, s44, 0
    s_nop 0
    buffer_load_dwordx4 v8, s[8:11], s45 offen lds
    s_add_u32 m0, s44, 4096
    s_add_u32 s45, s45, 114688
    buffer_load_dwordx4 v8, s[8:11], s45 offen lds
    s_add_u32 m0, s44, 8192
    s_add_u32 s45, s45, 114688
    buffer_load_dwordx4 v8, s[8:11], s45 offen lds
    s_add_u32 m0, s44, 12288
    s_add_u32 s45, s45, 114688
    buffer_load_dwordx4 v8, s[8:11], s45 offen lds
    s_add_u32 s33, s33, 49152
    s_cmp_eq_u32 s33, 147456
    s_cselect_b32 s33, 0, s33
    s_add_u32 s36, s36, 1
L_gl_ptop0:
    s_sub_u32 s46, s36, s59
    s_sub_u32 s38, s46, s24
    s_and_b32 s38, s38, 3
    s_cmp_le_u32 s38, 2
    s_cselect_b32 s39, -1, 0
    s_cmp_eq_u32 s38, 0
    s_cselect_b32 s39, 2, s39
    s_cmp_lt_u32 s46, s24
    s_cselect_b32 s39, 0, s39
    s_sub_u32 s38, s46, s38
    s_cmp_ge_i32 s38, s55
    s_cselect_b32 s39, 0, s39
    s_add_u32 s37, s46, s39
    s_add_u32 s37, s37, s53
    s_mul_i32 s45, s37, 458752
    s_lshl_b32 s38, s37, 14
    s_add_u32 s46, s38, s29
    s_add_u32 s58, s38, s28
    s_waitcnt vmcnt(12)
    s_barrier
    s_add_u32 s3, s33, s32
    s_add_u32 m0, s3, 16384
    s_nop 0
    buffer_load_dwordx4 v9, s[12:15], s46 offen offset:0 lds
    buffer_load_dwordx4 v9, s[12:15], s46 offen offset:1024 lds
    buffer_load_dwordx4 v9, s[12:15], s46 offen offset:2048 lds
    buffer_load_dwordx4 v9, s[12:15], s46 offen offset:3072 lds
    s_add_u32 s3, s33, s32
    s_add_u32 m0, s3, 32768
    s_nop 0
    buffer_load_dwordx4 v9, s[12:15], s58 offen offset:0 lds
    buffer_load_dwordx4 v9, s[12:15], s58 offen offset:1024 lds
    buffer_load_dwordx4 v9, s[12:15], s58 offen offset:2048 lds
    buffer_load_dwordx4 v9, s[12:15], s58 offen offset:3072 lds
    s_add_u32 s44, s33, s31
    s_add_u32 m0, s44, 0
    s_nop 0
    buffer_load_dwordx4 v8, s[8:11], s45 offen lds
    s_add_u32 m0, s44, 4096
    s_add_u32 s45, s45, 114688
    buffer_load_dwordx4 v8, s[8:11], s45 offen lds
    s_add_u32 m0, s44, 8192
    s_add_u32 s45, s45, 114688
    buffer_load_dwordx4 v8, s[8:11], s45 offen lds
    s_add_u32 m0, s44, 12288
    s_add_u32 s45, s45, 114688
    buffer_load_dwordx4 v8, s[8:11], s45 offen lds
    s_add_u32 s33, s33, 49152
    s_cmp_eq_u32 s33, 147456
    s_cselect_b32 s33, 0, s33
    s_add_u32 s36, s36, 1
    s_cmp_lt_u32 s36, 13
    s_cbranch_scc1 L_gl_ptop0
    s_sub_u32 s46, s36, s59
    s_sub_u32 s38, s46, s24
    s_and_b32 s38, s38, 3
    s_cmp_le_u32 s38, 2
    s_cselect_b32 s39, -1, 0
    s_cmp_eq_u32 s38, 0
    s_cselect_b32 s39, 2, s39
    s_cmp_lt_u32 s46, s24
    s_cselect_b32 s39, 0, s39
    s_sub_u32 s38, s46, s38
    s_cmp_ge_i32 s38, s55
    s_cselect_b32 s39, 0, s39
    s_add_u32 s37, s46, s39
    s_add_u32 s37, s37, s53
    s_mul_i32 s45, s37, 458752
    s_lshl_b32 s38, s37, 14
    s_add_u32 s46, s38, s29
    s_add_u32 s58, s38, s28
    s_waitcnt vmcnt(12)
    s_barrier
    buffer_load_dwordx2 v[10:11], v13, s[48:51], s34 offen sc1
    s_add_u32 s3, s33, s32
    s_add_u32 m0, s3, 16384
    s_nop 0
    buffer_load_dwordx4 v9, s[12:15], s46 offen offset:0 lds
    buffer_load_dwordx4 v9, s[12:15], s46 offen offset:1024 lds
    buffer_load_dwordx4 v9, s[12:15], s46 offen offset:2048 lds
    buffer_load_dwordx4 v9, s[12:15], s46 offen offset:3072 lds
    s_add_u32 s3, s33, s32
    s_add_u32 m0, s3, 32768
    s_nop 0
    buffer_load_dwordx4 v9, s[12:15], s58 offen offset:0 lds
    buffer_load_dwordx4 v9, s[12:15], s58 offen offset:1024 lds
    buffer_load_dwordx4 v9, s[12:15], s58 offen offset:2048 lds
    buffer_load_dwordx4 v9, s[12:15], s58 offen offset:3072 lds
    s_add_u32 s44, s33, s31
    s_add_u32 m0, s44, 0
    s_nop 0
    buffer_load_dwordx4 v8, s[8:11], s45 offen lds
    s_add_u32 m0, s44, 4096
    s_add_u32 s45, s45, 114688
    buffer_load_dwordx4 v8, s[8:11], s45 offen lds
    s_add_u32 m0, s44, 8192
    s_add_u32 s45, s45, 114688
    buffer_load_dwordx4 v8, s[8:11], s45 offen lds
    s_add_u32 m0, s44, 12288
    s_add_u32 s45, s45, 114688
    buffer_load_dwordx4 v8, s[8:11], s45 offen lds
    s_add_u32 s33, s33, 49152
    s_cmp_eq_u32 s33, 147456
    s_cselect_b32 s33, 0, s33
    s_add_u32 s36, s36, 1
    s_mov_b32 s43, s52
    s_mov_b32 s59, 14
    s_add_u32 s53, s53, 14
    s_sub_u32 s55, s43, 17
    s_sub_u32 s46, s36, s59
    s_sub_u32 s38, s46, s24
    s_and_b32 s38, s38, 3
    s_cmp_le_u32 s38, 2
    s_cselect_b32 s39, -1, 0
    s_cmp_eq_u32 s38, 0
    s_cselect_b32 s39, 2, s39
    s_cmp_lt_u32 s46, s24
    s_cselect_b32 s39, 0, s39
    s_sub_u32 s38, s46, s38
    s_cmp_ge_i32 s38, s55
    s_cselect_b32 s39, 0, s39
    s_add_u32 s37, s46, s39
    s_add_u32 s37, s37, s53
    s_mul_i32 s45, s37, 458752
    s_lshl_b32 s38, s37, 14
    s_add_u32 s46, s38, s29
    s_add_u32 s58, s38, s28
    s_waitcnt vmcnt(12)
    s_barrier
    s_mov_b32 s35, 131072
    s_branch L_fwq2_chk
L_fwq2_rd:
    buffer_load_dwordx2 v[10:11], v13, s[48:51], s34 offen sc1
    s_waitcnt vmcnt(0)
L_fwq2_chk:
    v_cmp_ne_u64 vcc, s[4:5], v[10:11]
    s_cbranch_vccz L_fwq2_ok
    s_sleep 2
    s_sub_u32 s35, s35, 1
    s_cmp_lg_u32 s35, 0
    s_cbranch_scc1 L_fwq2_rd
L_fwq2_ok:
    s_add_u32 s3, s33, s32
    s_add_u32 m0, s3, 16384
    s_nop 0
    buffer_load_dwordx4 v9, s[12:15], s46 offen offset:0 lds
    buffer_load_dwordx4 v9, s[12:15], s46 offen offset:1024 lds
    buffer_load_dwordx4 v9, s[12:15], s46 offen offset:2048 lds
    buffer_load_dwordx4 v9, s[12:15], s46 offen offset:3072 lds
    s_add_u32 s3, s33, s32
    s_add_u32 m0, s3, 32768
    s_nop 0
    buffer_load_dwordx4 v9, s[12:15], s58 offen offset:0 lds
    buffer_load_dwordx4 v9, s[12:15], s58 offen offset:1024 lds
    buffer_load_dwordx4 v9, s[12:15], s58 offen offset:2048 lds
    buffer_load_dwordx4 v9, s[12:15], s58 offen offset:3072 lds
    s_add_u32 s44, s33, s31
    s_add_u32 m0, s44, 0
    s_nop 0
    buffer_load_dwordx4 v8, s[8:11], s45 offen lds
    s_add_u32 m0, s44, 4096
    s_add_u32 s45, s45, 114688
    buffer_load_dwordx4 v8, s[8:11], s45 offen lds
    s_add_u32 m0, s44, 8192
    s_add_u32 s45, s45, 114688
    buffer_load_dwordx4 v8, s[8:11], s45 offen lds
    s_add_u32 m0, s44, 12288
    s_add_u32 s45, s45, 114688
    buffer_load_dwordx4 v8, s[8:11], s45 offen lds
    s_add_u32 s33, s33, 49152
    s_cmp_eq_u32 s33, 147456
    s_cselect_b32 s33, 0, s33
    s_add_u32 s36, s36, 1
    v_min_u32 v13, 15, v2
    v_lshlrev_b32 v14, 7, v13
    s_lshl_b32 s26, s23, 10
    s_add_u32 s26, s26, 28672
    s_lshl_b32 s27, s22, 10
    s_add_u32 s27, s27, 56320
    v_mov_b32 v3, s26
    v_mov_b32 v4, s27
    v_cmp_gt_u32 vcc, 8, v13
    s_nop 1
    v_cndmask_b32 v3, v4, v3, vcc
    v_add_u32 v13, v14, v3
    s_lshl_b32 s54, s22, 7
    s_add_u32 s54, s54, s26
    s_add_u32 s40, s54, 36864
    s_xor_b32 s41, s40, 128
    v_mov_b32 v3, s40
    v_cmp_gt_u32 vcc, 16, v2
    s_nop 1
    v_cndmask_b32 v13, v3, v13, vcc
    s_add_u32 s16, s56, 16777216
    s_addc_u32 s17, s57, 0
    s_mov_b32 s18, 4194304
    s_mov_b32 s19, 0x20000
    s_lshl_b32 s76, s22, 19
    s_lshl_b32 s42, s23, 18
    s_and_b32 s77, s23, 3
    s_lshl_b32 s27, s22, 1
    s_mov_b32 s52, 0
    s_mov_b32 s34, 0
L_gl_ptop:
    s_sub_u32 s46, s36, s59
    s_sub_u32 s38, s46, s24
    s_and_b32 s38, s38, 3
    s_cmp_le_u32 s38, 2
    s_cselect_b32 s39, -1, 0
    s_cmp_eq_u32 s38, 0
    s_cselect_b32 s39, 2, s39
    s_cmp_lt_u32 s46, s24
    s_cselect_b32 s39, 0, s39
    s_sub_u32 s38, s46, s38
    s_cmp_ge_i32 s38, s55
    s_cselect_b32 s39, 0, s39
    s_add_u32 s37, s46, s39
    s_add_u32 s37, s37, s53
    s_mul_i32 s45, s37, 458752
    s_lshl_b32 s38, s37, 14
    s_add_u32 s46, s38, s29
    s_add_u32 s58, s38, s28
    s_waitcnt vmcnt(12)
    s_barrier
    s_add_u32 s3, s33, s32
    s_add_u32 m0, s3, 16384
    s_nop 0
    buffer_load_dwordx4 v9, s[12:15], s46 offen offset:0 lds
    buffer_load_dwordx4 v9, s[12:15], s46 offen offset:1024 lds
    buffer_load_dwordx4 v9, s[12:15], s46 offen offset:2048 lds
    buffer_load_dwordx4 v9, s[12:15], s46 offen offset:3072 lds
    s_add_u32 s3, s33, s32
    s_add_u32 m0, s3, 32768
    s_nop 0
    buffer_load_dwordx4 v9, s[12:15], s58 offen offset:0 lds
    buffer_load_dwordx4 v9, s[12:15], s58 offen offset:1024 lds
    buffer_load_dwordx4 v9, s[12:15], s58 offen offset:2048 lds
    buffer_load_dwordx4 v9, s[12:15], s58 offen offset:3072 lds
    s_add_u32 s44, s33, s31
    s_add_u32 m0, s44, 0
    s_nop 0
    buffer_load_dwordx4 v8, s[8:11], s45 offen lds
    s_add_u32 m0, s44, 4096
    s_add_u32 s45, s45, 114688
    buffer_load_dwordx4 v8, s[8:11], s45 offen lds
    s_add_u32 m0, s44, 8192
    s_add_u32 s45, s45, 114688
    buffer_load_dwordx4 v8, s[8:11], s45 offen lds
    s_add_u32 m0, s44, 12288
    s_add_u32 s45, s45, 114688
    buffer_load_dwordx4 v8, s[8:11], s45 offen lds
    s_add_u32 s33, s33, 49152
    s_cmp_eq_u32 s33, 147456
    s_cselect_b32 s33, 0, s33
    s_add_u32 s36, s36, 1
    s_cmp_lt_u32 s36, s43
    s_cbranch_scc1 L_gl_ptop
    s_mov_b32 s36, 0
    s_mov_b32 s59, 0
    s_mov_b32 s53, 48
    s_mov_b32 s55, 5
    s_sub_u32 s46, s36, s59
    s_sub_u32 s38, s46, s24
    s_and_b32 s38, s38, 3
    s_cmp_le_u32 s38, 2
    s_cselect_b32 s39, -1, 0
    s_cmp_eq_u32 s38, 0
    s_cselect_b32 s39, 2, s39
    s_cmp_lt_u32 s46, s24
    s_cselect_b32 s39, 0, s39
    s_sub_u32 s38, s46, s38
    s_cmp_ge_i32 s38, s55
    s_cselect_b32 s39, 0, s39
    s_add_u32 s37, s46, s39
    s_add_u32 s37, s37, s53
    s_mul_i32 s45, s37, 458752
    s_lshl_b32 s38, s37, 14
    s_add_u32 s46, s38, s29
    s_add_u32 s58, s38, s28
    s_waitcnt vmcnt(12)
    s_barrier
    s_add_u32 s3, s33, s32
    s_add_u32 m0, s3, 16384
    s_nop 0
    buffer_load_dwordx4 v9, s[12:15], s58 offen offset:0 lds
    buffer_load_dwordx4 v9, s[12:15], s58 offen offset:1024 lds
    buffer_load_dwordx4 v9, s[12:15], s58 offen offset:2048 lds
    buffer_load_dwordx4 v9, s[12:15], s58 offen offset:3072 lds
    s_add_u32 s44, s33, s31
    s_add_u32 m0, s44, 0
    s_nop 0
    buffer_load_dwordx4 v8, s[8:11], s45 offen lds
    s_add_u32 m0, s44, 4096
    s_add_u32 s45, s45, 114688
    buffer_load_dwordx4 v8, s[8:11], s45 offen lds
    s_add_u32 m0, s44, 8192
    s_add_u32 s45, s45, 114688
    buffer_load_dwordx4 v8, s[8:11], s45 offen lds
    s_add_u32 m0, s44, 12288
    s_add_u32 s45, s45, 114688
    buffer_load_dwordx4 v8, s[8:11], s45 offen lds
    s_add_u32 s33, s33, 49152
    s_cmp_eq_u32 s33, 147456
    s_cselect_b32 s33, 0, s33
    s_add_u32 s36, s36, 1
    s_sub_u32 s46, s36, s59
    s_sub_u32 s38, s46, s24
    s_and_b32 s38, s38, 3
    s_cmp_le_u32 s38, 2
    s_cselect_b32 s39, -1, 0
    s_cmp_eq_u32 s38, 0
    s_cselect_b32 s39, 2, s39
    s_cmp_lt_u32 s46, s24
    s_cselect_b32 s39, 0, s39
    s_sub_u32 s38, s46, s38
    s_cmp_ge_i32 s38, s55
    s_cselect_b32 s39, 0, s39
    s_add_u32 s37, s46, s39
    s_add_u32 s37, s37, s53
    s_mul_i32 s45, s37, 458752
    s_lshl_b32 s38, s37, 14
    s_add_u32 s46, s38, s29
    s_add_u32 s58, s38, s28
    s_waitcnt vmcnt(8)
    s_barrier
    s_add_u32 s3, s33, s32
    s_add_u32 m0, s3, 16384
    s_nop 0
    buffer_load_dwordx4 v9, s[12:15], s58 offen offset:0 lds
    buffer_load_dwordx4 v9, s[12:15], s58 offen offset:1024 lds
    buffer_load_dwordx4 v9, s[12:15], s58 offen offset:2048 lds
    buffer_load_dwordx4 v9, s[12:15], s58 offen offset:3072 lds
    s_add_u32 s44, s33, s31
    s_add_u32 m0, s44, 0
    s_nop 0
    buffer_load_dwordx4 v8, s[8:11], s45 offen lds
    s_add_u32 m0, s44, 4096
    s_add_u32 s45, s45, 114688
    buffer_load_dwordx4 v8, s[8:11], s45 offen lds
    s_add_u32 m0, s44, 8192
    s_add_u32 s45, s45, 114688
    buffer_load_dwordx4 v8, s[8:11], s45 offen lds
    s_add_u32 m0, s44, 12288
    s_add_u32 s45, s45, 114688
    buffer_load_dwordx4 v8, s[8:11], s45 offen lds
    s_add_u32 s33, s33, 49152
    s_cmp_eq_u32 s33, 147456
    s_cselect_b32 s33, 0, s33
    s_add_u32 s36, s36, 1
    s_sub_u32 s46, s36, s59
    s_sub_u32 s38, s46, s24
    s_and_b32 s38, s38, 3
    s_cmp_le_u32 s38, 2
    s_cselect_b32 s39, -1, 0
    s_cmp_eq_u32 s38, 0
    s_cselect_b32 s39, 2, s39
    s_cmp_lt_u32 s46, s24
    s_cselect_b32 s39, 0, s39
    s_sub_u32 s38, s46, s38
    s_cmp_ge_i32 s38, s55
    s_cselect_b32 s39, 0, s39
    s_add_u32 s37, s46, s39
    s_add_u32 s37, s37, s53
    s_mul_i32 s45, s37, 458752
    s_lshl_b32 s38, s37, 14
    s_add_u32 s46, s38, s29
    s_add_u32 s58, s38, s28
    s_waitcnt vmcnt(8)
    s_barrier
    s_add_u32 s3, s33, s32
    s_add_u32 m0, s3, 16384
    s_nop 0
    buffer_load_dwordx4 v9, s[12:15], s58 offen offset:0 lds
    buffer_load_dwordx4 v9, s[12:15], s58 offen offset:1024 lds
    buffer_load_dwordx4 v9, s[12:15], s58 offen offset:2048 lds
    buffer_load_dwordx4 v9, s[12:15], s58 offen offset:3072 lds
    s_add_u32 s44, s33, s31
    s_add_u32 m0, s44, 0
    s_nop 0
    buffer_load_dwordx4 v8, s[8:11], s45 offen lds
    s_add_u32 m0, s44, 4096
    s_add_u32 s45, s45, 114688
    buffer_load_dwordx4 v8, s[8:11], s45 offen lds
    s_add_u32 m0, s44, 8192
    s_add_u32 s45, s45, 114688
    buffer_load_dwordx4 v8, s[8:11], s45 offen lds
    s_add_u32 m0, s44, 12288
    s_add_u32 s45, s45, 114688
    buffer_load_dwordx4 v8, s[8:11], s45 offen lds
    s_add_u32 s33, s33, 49152
    s_cmp_eq_u32 s33, 147456
    s_cselect_b32 s33, 0, s33
    s_add_u32 s36, s36, 1
    s_sub_u32 s46, s36, s59
    s_sub_u32 s38, s46, s24
    s_and_b32 s38, s38, 3
    s_cmp_le_u32 s38, 2
    s_cselect_b32 s39, -1, 0
    s_cmp_eq_u32 s38, 0
    s_cselect_b32 s39, 2, s39
    s_cmp_lt_u32 s46, s24
    s_cselect_b32 s39, 0, s39
    s_sub_u32 s38, s46, s38
    s_cmp_ge_i32 s38, s55
    s_cselect_b32 s39, 0, s39
    s_add_u32 s37, s46, s39
    s_add_u32 s37, s37, s53
    s_mul_i32 s45, s37, 458752
    s_lshl_b32 s38, s37, 14
    s_add_u32 s46, s38, s29
    s_add_u32 s58, s38, s28
    s_waitcnt vmcnt(8)
    s_barrier
    s_add_u32 s3, s33, s32
    s_add_u32 m0, s3, 16384
    s_nop 0
    buffer_load_dwordx4 v9, s[12:15], s58 offen offset:0 lds
    buffer_load_dwordx4 v9, s[12:15], s58 offen offset:1024 lds
    buffer_load_dwordx4 v9, s[12:15], s58 offen offset:2048 lds
    buffer_load_dwordx4 v9, s[12:15], s58 offen offset:3072 lds
    s_add_u32 s44, s33, s31
    s_add_u32 m0, s44, 0
    s_nop 0
    buffer_load_dwordx4 v8, s[8:11], s45 offen lds
    s_add_u32 m0, s44, 4096
    s_add_u32 s45, s45, 114688
    buffer_load_dwordx4 v8, s[8:11], s45 offen lds
    s_add_u32 m0, s44, 8192
    s_add_u32 s45, s45, 114688
    buffer_load_dwordx4 v8, s[8:11], s45 offen lds
    s_add_u32 m0, s44, 12288
    s_add_u32 s45, s45, 114688
    buffer_load_dwordx4 v8, s[8:11], s45 offen lds
    s_add_u32 s33, s33, 49152
    s_cmp_eq_u32 s33, 147456
    s_cselect_b32 s33, 0, s33
    s_add_u32 s36, s36, 1
    s_sub_u32 s46, s36, s59
    s_sub_u32 s38, s46, s24
    s_and_b32 s38, s38, 3
    s_cmp_le_u32 s38, 2
    s_cselect_b32 s39, -1, 0
    s_cmp_eq_u32 s38, 0
    s_cselect_b32 s39, 2, s39
    s_cmp_lt_u32 s46, s24
    s_cselect_b32 s39, 0, s39
    s_sub_u32 s38, s46, s38
    s_cmp_ge_i32 s38, s55
    s_cselect_b32 s39, 0, s39
    s_add_u32 s37, s46, s39
    s_add_u32 s37, s37, s53
    s_mul_i32 s45, s37, 458752
    s_lshl_b32 s38, s37, 14
    s_add_u32 s46, s38, s29
    s_add_u32 s58, s38, s28
    s_waitcnt vmcnt(8)
    s_barrier
    s_cmp_lg_u32 s30, 0
    s_cbranch_scc1 L_px_nf
    v_mov_b32 v24, s4
    v_mov_b32 v25, s5
    v_mov_b32 v26, 0
    s_mov_b64 exec, 1
    buffer_store_dwordx2 v[24:25], v26, s[48:51], s41 offen offset:0 sc1
    s_mov_b64 exec, -1
L_px_nf:
    buffer_load_dwordx2 v[10:11], v13, s[48:51], s34 offen sc1
    s_add_u32 s3, s33, s32
    s_add_u32 m0, s3, 16384
    s_nop 0
    buffer_load_dwordx4 v9, s[12:15], s58 offen offset:0 lds
    buffer_load_dwordx4 v9, s[12:15], s58 offen offset:1024 lds
    buffer_load_dwordx4 v9, s[12:15], s58 offen offset:2048 lds
    buffer_load_dwordx4 v9, s[12:15], s58 offen offset:3072 lds
    s_add_u32 s44, s33, s31
    s_add_u32 m0, s44, 0
    s_nop 0
    buffer_load_dwordx4 v8, s[8:11], s45 offen lds
    s_add_u32 m0, s44, 4096
    s_add_u32 s45, s45, 114688
    buffer_load_dwordx4 v8, s[8:11], s45 offen lds
    s_add_u32 m0, s44, 8192
    s_add_u32 s45, s45, 114688
    buffer_load_dwordx4 v8, s[8:11], s45 offen lds
    s_add_u32 m0, s44, 12288
    s_add_u32 s45, s45, 114688
    buffer_load_dwordx4 v8, s[8:11], s45 offen lds
    s_add_u32 s33, s33, 49152
    s_cmp_eq_u32 s33, 147456
    s_cselect_b32 s33, 0, s33
    s_add_u32 s36, s36, 1
    s_sub_u32 s46, s36, s59
    s_sub_u32 s38, s46, s24
    s_and_b32 s38, s38, 3
    s_cmp_le_u32 s38, 2
    s_cselect_b32 s39, -1, 0
    s_cmp_eq_u32 s38, 0
    s_cselect_b32 s39, 2, s39
    s_cmp_lt_u32 s46, s24
    s_cselect_b32 s39, 0, s39
    s_sub_u32 s38, s46, s38
    s_cmp_ge_i32 s38, s55
    s_cselect_b32 s39, 0, s39
    s_add_u32 s37, s46, s39
    s_add_u32 s37, s37, s53
    s_mul_i32 s45, s37, 458752
    s_lshl_b32 s38, s37, 14
    s_add_u32 s46, s38, s29
    s_add_u32 s58, s38, s28
    s_waitcnt vmcnt(8)
    s_barrier
    v_cmp_eq_u64 vcc, s[4:5], v[10:11]
    s_nop 1
    s_mov_b32 s52, vcc_lo
    s_add_u32 s3, s33, s32
    s_add_u32 m0, s3, 16384
    s_nop 0
    buffer_load_dwordx4 v9, s[12:15], s58 offen offset:0 lds
    buffer_load_dwordx4 v9, s[12:15], s58 offen offset:1024 lds
    buffer_load_dwordx4 v9, s[12:15], s58 offen offset:2048 lds
    buffer_load_dwordx4 v9, s[12:15], s58 offen offset:3072 lds
    s_add_u32 s44, s33, s31
    s_add_u32 m0, s44, 0
    s_nop 0
    buffer_load_dwordx4 v8, s[8:11], s45 offen lds
    s_add_u32 m0, s44, 4096
    s_add_u32 s45, s45, 114688
    buffer_load_dwordx4 v8, s[8:11], s45 offen lds
    s_add_u32 m0, s44, 8192
    s_add_u32 s45, s45, 114688
    buffer_load_dwordx4 v8, s[8:11], s45 offen lds
    s_add_u32 m0, s44, 12288
    s_add_u32 s45, s45, 114688
    buffer_load_dwordx4 v8, s[8:11], s45 offen lds
    s_add_u32 s33, s33, 49152
    s_cmp_eq_u32 s33, 147456
    s_cselect_b32 s33, 0, s33
    s_add_u32 s36, s36, 1
    s_sub_u32 s46, s36, s59
    s_sub_u32 s38, s46, s24
    s_and_b32 s38, s38, 3
    s_cmp_le_u32 s38, 2
    s_cselect_b32 s39, -1, 0
    s_cmp_eq_u32 s38, 0
    s_cselect_b32 s39, 2, s39
    s_cmp_lt_u32 s46, s24
    s_cselect_b32 s39, 0, s39
    s_sub_u32 s38, s46, s38
    s_cmp_ge_i32 s38, s55
    s_cselect_b32 s39, 0, s39
    s_add_u32 s37, s46, s39
    s_add_u32 s37, s37, s53
    s_mul_i32 s45, s37, 458752
    s_lshl_b32 s38, s37, 14
    s_add_u32 s46, s38, s29
    s_add_u32 s58, s38, s28
    s_waitcnt vmcnt(8)
    s_barrier
    s_add_u32 s3, s33, s32
    s_add_u32 m0, s3, 16384
    s_nop 0
    buffer_load_dwordx4 v9, s[12:15], s58 offen offset:0 lds
    buffer_load_dwordx4 v9, s[12:15], s58 offen offset:1024 lds
    buffer_load_dwordx4 v9, s[12:15], s58 offen offset:2048 lds
    buffer_load_dwordx4 v9, s[12:15], s58 offen offset:3072 lds
    s_add_u32 s44, s33, s31
    s_add_u32 m0, s44, 0
    s_nop 0
    buffer_load_dwordx4 v8, s[8:11], s45 offen lds
    s_add_u32 m0, s44, 4096
    s_add_u32 s45, s45, 114688
    buffer_load_dwordx4 v8, s[8:11], s45 offen lds
    s_add_u32 m0, s44, 8192
    s_add_u32 s45, s45, 114688
    buffer_load_dwordx4 v8, s[8:11], s45 offen lds
    s_add_u32 m0, s44, 12288
    s_add_u32 s45, s45, 114688
    buffer_load_dwordx4 v8, s[8:11], s45 offen lds
    s_add_u32 s33, s33, 49152
    s_cmp_eq_u32 s33, 147456
    s_cselect_b32 s33, 0, s33
    s_add_u32 s36, s36, 1
    s_sub_u32 s46, s36, s59
    s_sub_u32 s38, s46, s24
    s_and_b32 s38, s38, 3
    s_cmp_le_u32 s38, 2
    s_cselect_b32 s39, -1, 0
    s_cmp_eq_u32 s38, 0
    s_cselect_b32 s39, 2, s39
    s_cmp_lt_u32 s46, s24
    s_cselect_b32 s39, 0, s39
    s_sub_u32 s38, s46, s38
    s_cmp_ge_i32 s38, s55
    s_cselect_b32 s39, 0, s39
    s_add_u32 s37, s46, s39
    s_add_u32 s37, s37, s53
    s_mul_i32 s45, s37, 458752
    s_lshl_b32 s38, s37, 14
    s_add_u32 s46, s38, s29
    s_add_u32 s58, s38, s28
    s_waitcnt vmcnt(8)
    s_barrier
    buffer_load_dwordx2 v[10:11], v13, s[48:51], s34 offen sc1
    s_add_u32 s3, s33, s32
    s_add_u32 m0, s3, 16384
    s_nop 0
    buffer_load_dwordx4 v9, s[12:15], s58 offen offset:0 lds
    buffer_load_dwordx4 v9, s[12:15], s58 offen offset:1024 lds
    buffer_load_dwordx4 v9, s[12:15], s58 offen offset:2048 lds
    buffer_load_dwordx4 v9, s[12:15], s58 offen offset:3072 lds
    s_add_u32 s44, s33, s31
    s_add_u32 m0, s44, 0
    s_nop 0
    buffer_load_dwordx4 v8, s[8:11], s45 offen lds
    s_add_u32 m0, s44, 4096
    s_add_u32 s45, s45, 114688
    buffer_load_dwordx4 v8, s[8:11], s45 offen lds
    s_add_u32 m0, s44, 8192
    s_add_u32 s45, s45, 114688
    buffer_load_dwordx4 v8, s[8:11], s45 offen lds
    s_add_u32 m0, s44, 12288
    s_add_u32 s45, s45, 114688
    buffer_load_dwordx4 v8, s[8:11], s45 offen lds
    s_add_u32 s33, s33, 49152
    s_cmp_eq_u32 s33, 147456
    s_cselect_b32 s33, 0, s33
    s_add_u32 s36, s36, 1
    s_add_u32 s12, s56, 8388608
    s_addc_u32 s13, s57, 0
    s_mov_b32 s14, 7340032
    s_mov_b32 s15, 0x20000
    s_add_u32 s37, s27, 0
    s_lshl_b32 s45, s37, 14
    s_add_u32 s45, s45, s42
    s_lshl_b32 s46, s37, 15
    s_add_u32 s46, s46, s76
    s_add_u32 s47, s46, 16384
    s_waitcnt vmcnt(8)
    s_cmp_lg_u32 s30, 0
    s_cbranch_scc1 L_fpx_ok
    v_cmp_eq_u64 vcc, s[4:5], v[10:11]
    s_nop 1
    s_mov_b32 s52, vcc_lo
    s_mov_b32 s38, 0x10000
    s_andn2_b32 s39, s38, s52
    s_cbranch_scc0 L_fpx_ok
    s_mov_b32 s35, 131072
L_fpx_rd:
    buffer_load_dwordx2 v[10:11], v13, s[48:51], s34 offen sc1
    s_waitcnt vmcnt(0)
    v_cmp_eq_u64 vcc, s[4:5], v[10:11]
    s_nop 1
    s_mov_b32 s52, vcc_lo
    s_andn2_b32 s39, s38, s52
    s_cbranch_scc0 L_fpx_ok
    s_sleep 2
    s_sub_u32 s35, s35, 1
    s_cmp_lg_u32 s35, 0
    s_cbranch_scc1 L_fpx_rd
L_fpx_ok:
    s_barrier
    s_lshr_b32 s38, s37, 1
    s_lshl_b32 s38, 256, s38
    s_andn2_b32 s39, s38, s52
    s_cbranch_scc0 L_fx0_ok
    s_mov_b32 s35, 131072
L_fx0_rd:
    buffer_load_dwordx2 v[10:11], v13, s[48:51], s34 offen sc1
    s_waitcnt vmcnt(0)
    v_cmp_eq_u64 vcc, s[4:5], v[10:11]
    s_nop 1
    s_mov_b32 s52, vcc_lo
    s_andn2_b32 s39, s38, s52
    s_cbranch_scc0 L_fx0_ok
    s_sleep 2
    s_sub_u32 s35, s35, 1
    s_cmp_lg_u32 s35, 0
    s_cbranch_scc1 L_fx0_rd
L_fx0_ok:
    s_add_u32 s3, s33, s32
    s_add_u32 m0, s3, 16384
    s_nop 0
    buffer_load_dwordx4 v9, s[16:19], s46 offen offset:0 lds
    buffer_load_dwordx4 v9, s[16:19], s46 offen offset:1024 lds
    buffer_load_dwordx4 v9, s[16:19], s46 offen offset:2048 lds
    buffer_load_dwordx4 v9, s[16:19], s46 offen offset:3072 lds
    s_add_u32 s3, s33, s32
    s_add_u32 m0, s3, 32768
    s_nop 0
    buffer_load_dwordx4 v9, s[16:19], s47 offen offset:0 lds
    buffer_load_dwordx4 v9, s[16:19], s47 offen offset:1024 lds
    buffer_load_dwordx4 v9, s[16:19], s47 offen offset:2048 lds
    buffer_load_dwordx4 v9, s[16:19], s47 offen offset:3072 lds
    s_add_u32 s33, s33, 49152
    s_cmp_eq_u32 s33, 147456
    s_cselect_b32 s33, 0, s33
    s_add_u32 s37, s27, 1
    s_lshl_b32 s45, s37, 14
    s_add_u32 s45, s45, s42
    s_lshl_b32 s46, s37, 15
    s_add_u32 s46, s46, s76
    s_add_u32 s47, s46, 16384
    s_waitcnt vmcnt(8)
    s_barrier
    s_add_u32 s3, s33, s32
    s_add_u32 m0, s3, 16384
    s_nop 0
    buffer_load_dwordx4 v9, s[16:19], s46 offen offset:0 lds
    buffer_load_dwordx4 v9, s[16:19], s46 offen offset:1024 lds
    buffer_load_dwordx4 v9, s[16:19], s46 offen offset:2048 lds
    buffer_load_dwordx4 v9, s[16:19], s46 offen offset:3072 lds
    s_add_u32 s3, s33, s32
    s_add_u32 m0, s3, 32768
    s_nop 0
    buffer_load_dwordx4 v9, s[16:19], s47 offen offset:0 lds
    buffer_load_dwordx4 v9, s[16:19], s47 offen offset:1024 lds
    buffer_load_dwordx4 v9, s[16:19], s47 offen offset:2048 lds
    buffer_load_dwordx4 v9, s[16:19], s47 offen offset:3072 lds
    s_add_u32 s33, s33, 49152
    s_cmp_eq_u32 s33, 147456
    s_cselect_b32 s33, 0, s33
    s_mov_b32 s36, 0
    s_sub_u32 s38, s36, s77
    s_and_b32 s38, s38, 3
    s_cmp_le_u32 s38, 2
    s_cselect_b32 s39, -1, 0
    s_cmp_eq_u32 s38, 0
    s_cselect_b32 s39, 2, s39
    s_cmp_lt_u32 s36, s77
    s_cselect_b32 s39, 0, s39
    s_sub_u32 s38, s36, s38
    s_cmp_ge_i32 s38, 11
    s_cselect_b32 s39, 0, s39
    s_add_u32 s37, s36, s39
    s_add_u32 s37, s37, 2
    s_and_b32 s38, s37, 6
    s_lshl_b32 s38, s38, 1
    s_add_u32 s38, s38, s27
    s_and_b32 s38, s38, 15
    s_lshr_b32 s39, s37, 2
    s_and_b32 s39, s39, 2
    s_xor_b32 s38, s38, s39
    s_and_b32 s37, s37, 1
    s_or_b32 s37, s37, s38
    s_lshl_b32 s45, s37, 14
    s_add_u32 s45, s45, s42
    s_lshl_b32 s46, s37, 15
    s_add_u32 s46, s46, s76
    s_add_u32 s47, s46, 16384
    s_lshr_b32 s38, s37, 1
    s_lshl_b32 s38, 256, s38
    s_andn2_b32 s39, s38, s52
    s_cbranch_scc0 L_fx2_ok
    s_mov_b32 s35, 131072
L_fx2_rd:
    buffer_load_dwordx2 v[10:11], v13, s[48:51], s34 offen sc1
    s_waitcnt vmcnt(0)
    v_cmp_eq_u64 vcc, s[4:5], v[10:11]
    s_nop 1
    s_mov_b32 s52, vcc_lo
    s_andn2_b32 s39, s38, s52
    s_cbranch_scc0 L_fx2_ok
    s_sleep 2
    s_sub_u32 s35, s35, 1
    s_cmp_lg_u32 s35, 0
    s_cbranch_scc1 L_fx2_rd
L_fx2_ok:
    s_waitcnt vmcnt(8)
    s_barrier
    s_add_u32 s3, s33, s32
    s_add_u32 m0, s3, 16384
    s_nop 0
    buffer_load_dwordx4 v9, s[16:19], s46 offen offset:0 lds
    buffer_load_dwordx4 v9, s[16:19], s46 offen offset:1024 lds
    buffer_load_dwordx4 v9, s[16:19], s46 offen offset:2048 lds
    buffer_load_dwordx4 v9, s[16:19], s46 offen offset:3072 lds
    s_add_u32 s3, s33, s32
    s_add_u32 m0, s3, 32768
    s_nop 0
    buffer_load_dwordx4 v9, s[16:19], s47 offen offset:0 lds
    buffer_load_dwordx4 v9, s[16:19], s47 offen offset:1024 lds
    buffer_load_dwordx4 v9, s[16:19], s47 offen offset:2048 lds
    buffer_load_dwordx4 v9, s[16:19], s47 offen offset:3072 lds
    s_waitcnt vmcnt(8)
    s_barrier
    s_cmp_lg_u32 s30, 0
    s_cbranch_scc1 L_pc_nf
    v_mov_b32 v24, s4
    v_mov_b32 v25, s5
    v_mov_b32 v26, 0
    s_mov_b64 exec, 1
    buffer_store_dwordx2 v[24:25], v26, s[48:51], s54 offen offset:0 sc1
    s_mov_b64 exec, -1
L_pc_nf:
    s_lshr_b32 s38, s37, 1
    s_lshl_b32 s38, 257, s38
    s_andn2_b32 s39, s38, s52
    s_cbranch_scc0 L_fw0_ok
    s_mov_b32 s35, 131072
L_fw0_rd:
    buffer_load_dwordx2 v[10:11], v13, s[48:51], s34 offen sc1
    s_waitcnt vmcnt(0)
    v_cmp_eq_u64 vcc, s[4:5], v[10:11]
    s_nop 1
    s_mov_b32 s52, vcc_lo
    s_andn2_b32 s39, s38, s52
    s_cbranch_scc0 L_fw0_ok
    s_sleep 2
    s_sub_u32 s35, s35, 1
    s_cmp_lg_u32 s35, 0
    s_cbranch_scc1 L_fw0_rd
L_fw0_ok:
    s_add_u32 s3, s33, s32
    s_add_u32 m0, s3, 0
    s_nop 0
    buffer_load_dwordx4 v9, s[12:15], s45 offen offset:0 lds
    buffer_load_dwordx4 v9, s[12:15], s45 offen offset:1024 lds
    buffer_load_dwordx4 v9, s[12:15], s45 offen offset:2048 lds
    buffer_load_dwordx4 v9, s[12:15], s45 offen offset:3072 lds
    s_add_u32 s33, s33, 49152
    s_cmp_eq_u32 s33, 147456
    s_cselect_b32 s33, 0, s33
    s_add_u32 s36, s36, 1
    s_sub_u32 s38, s36, s77
    s_and_b32 s38, s38, 3
    s_cmp_le_u32 s38, 2
    s_cselect_b32 s39, -1, 0
    s_cmp_eq_u32 s38, 0
    s_cselect_b32 s39, 2, s39
    s_cmp_lt_u32 s36, s77
    s_cselect_b32 s39, 0, s39
    s_sub_u32 s38, s36, s38
    s_cmp_ge_i32 s38, 11
    s_cselect_b32 s39, 0, s39
    s_add_u32 s37, s36, s39
    s_add_u32 s37, s37, 2
    s_and_b32 s38, s37, 6
    s_lshl_b32 s38, s38, 1
    s_add_u32 s38, s38, s27
    s_and_b32 s38, s38, 15
    s_lshr_b32 s39, s37, 2
    s_and_b32 s39, s39, 2
    s_xor_b32 s38, s38, s39
    s_and_b32 s37, s37, 1
    s_or_b32 s37, s37, s38
    s_lshl_b32 s45, s37, 14
    s_add_u32 s45, s45, s42
    s_lshl_b32 s46, s37, 15
    s_add_u32 s46, s46, s76
    s_add_u32 s47, s46, 16384
    s_lshr_b32 s38, s37, 1
    s_lshl_b32 s38, 257, s38
    s_andn2_b32 s39, s38, s52
    s_cbranch_scc0 L_fw1_ok
    s_mov_b32 s35, 131072
L_fw1_rd:
    buffer_load_dwordx2 v[10:11], v13, s[48:51], s34 offen sc1
    s_waitcnt vmcnt(0)
    v_cmp_eq_u64 vcc, s[4:5], v[10:11]
    s_nop 1
    s_mov_b32 s52, vcc_lo
    s_andn2_b32 s39, s38, s52
    s_cbranch_scc0 L_fw1_ok
    s_sleep 2
    s_sub_u32 s35, s35, 1
    s_cmp_lg_u32 s35, 0
    s_cbranch_scc1 L_fw1_rd
L_fw1_ok:
    s_add_u32 s3, s33, s32
    s_add_u32 m0, s3, 0
    s_nop 0
    buffer_load_dwordx4 v9, s[12:15], s45 offen offset:0 lds
    buffer_load_dwordx4 v9, s[12:15], s45 offen offset:1024 lds
    buffer_load_dwordx4 v9, s[12:15], s45 offen offset:2048 lds
    buffer_load_dwordx4 v9, s[12:15], s45 offen offset:3072 lds
    s_add_u32 s3, s33, s32
    s_add_u32 m0, s3, 16384
    s_nop 0
    buffer_load_dwordx4 v9, s[16:19], s46 offen offset:0 lds
    buffer_load_dwordx4 v9, s[16:19], s46 offen offset:1024 lds
    buffer_load_dwordx4 v9, s[16:19], s46 offen offset:2048 lds
    buffer_load_dwordx4 v9, s[16:19], s46 offen offset:3072 lds
    s_add_u32 s3, s33, s32
    s_add_u32 m0, s3, 32768
    s_nop 0
    buffer_load_dwordx4 v9, s[16:19], s47 offen offset:0 lds
    buffer_load_dwordx4 v9, s[16:19], s47 offen offset:1024 lds
    buffer_load_dwordx4 v9, s[16:19], s47 offen offset:2048 lds
    buffer_load_dwordx4 v9, s[16:19], s47 offen offset:3072 lds
    s_add_u32 s33, s33, 49152
    s_cmp_eq_u32 s33, 147456
    s_cselect_b32 s33, 0, s33
    s_add_u32 s36, s36, 1
L_gc_ptop:
    s_sub_u32 s38, s36, s77
    s_and_b32 s38, s38, 3
    s_cmp_le_u32 s38, 2
    s_cselect_b32 s39, -1, 0
    s_cmp_eq_u32 s38, 0
    s_cselect_b32 s39, 2, s39
    s_cmp_lt_u32 s36, s77
    s_cselect_b32 s39, 0, s39
    s_sub_u32 s38, s36, s38
    s_cmp_ge_i32 s38, 11
    s_cselect_b32 s39, 0, s39
    s_add_u32 s37, s36, s39
    s_add_u32 s37, s37, 2
    s_and_b32 s38, s37, 6
    s_lshl_b32 s38, s38, 1
    s_add_u32 s38, s38, s27
    s_and_b32 s38, s38, 15
    s_lshr_b32 s39, s37, 2
    s_and_b32 s39, s39, 2
    s_xor_b32 s38, s38, s39
    s_and_b32 s37, s37, 1
    s_or_b32 s37, s37, s38
    s_lshl_b32 s45, s37, 14
    s_add_u32 s45, s45, s42
    s_lshl_b32 s46, s37, 15
    s_add_u32 s46, s46, s76
    s_add_u32 s47, s46, 16384
    s_waitcnt vmcnt(12)
    s_barrier
    s_lshr_b32 s38, s37, 1
    s_lshl_b32 s38, 257, s38
    s_andn2_b32 s39, s38, s52
    s_cbranch_scc0 L_fw2_ok
    s_mov_b32 s35, 131072
L_fw2_rd:
    buffer_load_dwordx2 v[10:11], v13, s[48:51], s34 offen sc1
    s_waitcnt vmcnt(0)
    v_cmp_eq_u64 vcc, s[4:5], v[10:11]
    s_nop 1
    s_mov_b32 s52, vcc_lo
    s_andn2_b32 s39, s38, s52
    s_cbranch_scc0 L_fw2_ok
    s_sleep 2
    s_sub_u32 s35, s35, 1
    s_cmp_lg_u32 s35, 0
    s_cbranch_scc1 L_fw2_rd
L_fw2_ok:
    s_add_u32 s3, s33, s32
    s_add_u32 m0, s3, 0
    s_nop 0
    buffer_load_dwordx4 v9, s[12:15], s45 offen offset:0 lds
    buffer_load_dwordx4 v9, s[12:15], s45 offen offset:1024 lds
    buffer_load_dwordx4 v9, s[12:15], s45 offen offset:2048 lds
    buffer_load_dwordx4 v9, s[12:15], s45 offen offset:3072 lds
    s_add_u32 s3, s33, s32
    s_add_u32 m0, s3, 16384
    s_nop 0
    buffer_load_dwordx4 v9, s[16:19], s46 offen offset:0 lds
    buffer_load_dwordx4 v9, s[16:19], s46 offen offset:1024 lds
    buffer_load_dwordx4 v9, s[16:19], s46 offen offset:2048 lds
    buffer_load_dwordx4 v9, s[16:19], s46 offen offset:3072 lds
    s_add_u32 s3, s33, s32
    s_add_u32 m0, s3, 32768
    s_nop 0
    buffer_load_dwordx4 v9, s[16:19], s47 offen offset:0 lds
    buffer_load_dwordx4 v9, s[16:19], s47 offen offset:1024 lds
    buffer_load_dwordx4 v9, s[16:19], s47 offen offset:2048 lds
    buffer_load_dwordx4 v9, s[16:19], s47 offen offset:3072 lds
    s_add_u32 s33, s33, 49152
    s_cmp_eq_u32 s33, 147456
    s_cselect_b32 s33, 0, s33
    s_add_u32 s36, s36, 1
    s_cmp_lt_u32 s36, 14
    s_cbranch_scc1 L_gc_ptop
    s_waitcnt vmcnt(12)
    s_barrier
    s_waitcnt vmcnt(0)
    s_barrier
    s_or_b32 s26, s2, s30
    s_cmp_lg_u32 s26, 0
    s_cbranch_scc1 L_pc_end
    v_min_u32 v13, 63, v2
    v_lshlrev_b32 v13, 7, v13
    s_mov_b32 s34, 57344
    s_mov_b32 s35, 131072
L_fall_rd:
    buffer_load_dwordx2 v[10:11], v13, s[48:51], s34 offen sc1
    s_waitcnt vmcnt(0)
L_fall_chk:
    v_cmp_ne_u64 vcc, s[4:5], v[10:11]
    s_cbranch_vccz L_fall_ok
    s_sleep 2
    s_sub_u32 s35, s35, 1
    s_cmp_lg_u32 s35, 0
    s_cbranch_scc1 L_fall_rd
L_fall_ok:
    s_mov_b32 s26, 94208
    v_mov_b32 v24, s4
    v_mov_b32 v25, s5
    v_mov_b32 v26, 0
    s_mov_b64 exec, 1
    buffer_store_dwordx2 v[24:25], v26, s[48:51], s26 offen offset:0 sc1
    s_mov_b64 exec, -1
L_pc_end:
    s_endpgm
L_spare:
    s_mov_b32 s8, s68
    s_mov_b32 s9, s69
    s_mov_b32 s10, 2097152
    s_mov_b32 s11, 0x20000
    s_mov_b32 s12, s60
    s_mov_b32 s13, s61
    s_mov_b32 s14, 4194304
    s_mov_b32 s15, 0x20000
    s_add_u32 s16, s56, 16777216
    s_addc_u32 s17, s57, 0
    s_mov_b32 s18, 4194304
    s_mov_b32 s19, 0x20000
    s_mov_b32 s22, s20
    s_sub_u32 s24, s21, 28
    s_and_b32 s23, s22, 1
    s_lshl_b32 s26, s24, 1
    s_or_b32 s23, s23, s26
    s_mov_b32 s53, 0
    s_cmp_ge_u32 s25, 4
    s_cbranch_scc1 L_pb
    s_lshr_b32 s30, s25, 1
    s_and_b32 s31, s25, 1
    v_lshrrev_b32 v3, 4, v2
    v_and_b32 v4, 15, v2
    v_lshrrev_b32 v5, 2, v4
    v_and_b32 v6, 3, v4
    v_lshlrev_b32 v7, 3, v3
    v_add_u32 v7, v7, v5
    v_lshlrev_b32 v7, 8, v7
    v_lshlrev_b32 v6, 3, v6
    v_add_u32 v7, v7, v6
    v_and_b32 v6, 1, v3
    v_lshlrev_b32 v6, 2, v6
    v_or_b32 v6, v6, v5
    s_lshl_b32 s26, s31, 2
    v_xor_b32 v6, s26, v6
    v_xor_b32 v5, 0, v6
    v_lshlrev_b32 v5, 5, v5
    v_add_u32 v16, v7, v5
    v_xor_b32 v5, 1, v6
    v_lshlrev_b32 v5, 5, v5
    v_add_u32 v17, v7, v5
    v_xor_b32 v5, 2, v6
    v_lshlrev_b32 v5, 5, v5
    v_add_u32 v18, v7, v5
    v_xor_b32 v5, 3, v6
    v_lshlrev_b32 v5, 5, v5
    v_add_u32 v19, v7, v5
    v_lshrrev_b32 v5, 1, v4
    v_xor_b32 v5, v5, v3
    v_lshlrev_b32 v5, 4, v5
    s_lshl_b32 s26, s30, 14
    s_add_u32 s26, s26, 16384
    v_lshlrev_b32 v6, 7, v4
    v_add3_u32 v20, v5, v6, s26
    v_xor_b32 v21, 64, v20
L_bl:
    v_mov_b64 v[28:29], 0
    v_mov_b64 v[30:31], 0
    v_mov_b64 v[32:33], 0
    v_mov_b64 v[34:35], 0
    v_mov_b64 v[36:37], 0
    v_mov_b64 v[38:39], 0
    v_mov_b64 v[40:41], 0
    v_mov_b64 v[42:43], 0
    v_mov_b64 v[44:45], 0
    v_mov_b64 v[46:47], 0
    v_mov_b64 v[48:49], 0
    v_mov_b64 v[50:51], 0
    v_mov_b64 v[52:53], 0
    v_mov_b64 v[54:55], 0
    v_mov_b64 v[56:57], 0
    v_mov_b64 v[58:59], 0
    v_mov_b64 v[60:61], 0
    v_mov_b64 v[62:63], 0
    v_mov_b64 v[64:65], 0
    v_mov_b64 v[66:67], 0
    v_mov_b64 v[68:69], 0
    v_mov_b64 v[70:71], 0
    v_mov_b64 v[72:73], 0
    v_mov_b64 v[74:75], 0
    v_mov_b64 v[76:77], 0
    v_mov_b64 v[78:79], 0
    v_mov_b64 v[80:81], 0
    v_mov_b64 v[82:83], 0
    v_mov_b64 v[84:85], 0
    v_mov_b64 v[86:87], 0
    v_mov_b64 v[88:89], 0
    v_mov_b64 v[90:91], 0
    v_mov_b64 v[92:93], 0
    v_mov_b64 v[94:95], 0
    v_mov_b64 v[96:97], 0
    v_mov_b64 v[98:99], 0
    v_mov_b64 v[100:101], 0
    v_mov_b64 v[102:103], 0
    v_mov_b64 v[104:105], 0
    v_mov_b64 v[106:107], 0
    v_mov_b64 v[108:109], 0
    v_mov_b64 v[110:111], 0
    v_mov_b64 v[112:113], 0
    v_mov_b64 v[114:115], 0
    v_mov_b64 v[116:117], 0
    v_mov_b64 v[118:119], 0
    v_mov_b64 v[120:121], 0
    v_mov_b64 v[122:123], 0
    v_mov_b64 v[124:125], 0
    v_mov_b64 v[126:127], 0
    v_mov_b64 v[128:129], 0
    v_mov_b64 v[130:131], 0
    v_mov_b64 v[132:133], 0
    v_mov_b64 v[134:135], 0
    v_mov_b64 v[136:137], 0
    v_mov_b64 v[138:139], 0
    v_mov_b64 v[140:141], 0
    v_mov_b64 v[142:143], 0
    v_mov_b64 v[144:145], 0
    v_mov_b64 v[146:147], 0
    v_mov_b64 v[148:149], 0
    v_mov_b64 v[150:151], 0
    v_mov_b64 v[152:153], 0
    v_mov_b64 v[154:155], 0
    v_add_u32 v8, s33, v16
    v_add_u32 v9, s33, v17
    v_add_u32 v10, s33, v18
    v_add_u32 v11, s33, v19
    v_add_u32 v12, s33, v20
    v_add_u32 v13, s33, v21
    s_barrier
    ds_read_b64_tr_b16 v[188:189], v8 offset:0
    ds_read_b64_tr_b16 v[190:191], v8 offset:1024
    ds_read_b128 v[156:159], v12 offset:0
    ds_read_b128 v[160:163], v12 offset:2048
    ds_read_b64_tr_b16 v[192:193], v9 offset:0
    ds_read_b64_tr_b16 v[194:195], v9 offset:1024
    ds_read_b128 v[164:167], v12 offset:4096
    ds_read_b128 v[168:171], v12 offset:6144
    ds_read_b64_tr_b16 v[196:197], v10 offset:0
    ds_read_b64_tr_b16 v[198:199], v10 offset:1024
    ds_read_b128 v[172:175], v12 offset:8192
    ds_read_b128 v[176:179], v12 offset:10240
    ds_read_b64_tr_b16 v[200:201], v11 offset:0
    ds_read_b64_tr_b16 v[202:203], v11 offset:1024
    ds_read_b128 v[180:183], v12 offset:12288
    ds_read_b128 v[184:187], v12 offset:14336
    s_mov_b32 s36, 16
    s_branch L_gb_mid
L_gb_top:
    v_mfma_f32_16x16x32_bf16 v[28:31], v[236:239], v[204:207], v[28:31]
    v_mfma_f32_16x16x32_bf16 v[32:35], v[240:243], v[204:207], v[32:35]
    s_barrier
    ds_read_b64_tr_b16 v[188:189], v8 offset:0
    v_mfma_f32_16x16x32_bf16 v[36:39], v[244:247], v[204:207], v[36:39]
    ds_read_b64_tr_b16 v[190:191], v8 offset:1024
    v_mfma_f32_16x16x32_bf16 v[40:43], v[248:251], v[204:207], v[40:43]
    ds_read_b128 v[156:159], v12 offset:0
    v_mfma_f32_16x16x32_bf16 v[56:59], v[248:251], v[208:211], v[56:59]
    ds_read_b128 v[160:163], v12 offset:2048
    v_mfma_f32_16x16x32_bf16 v[52:55], v[244:247], v[208:211], v[52:55]
    ds_read_b64_tr_b16 v[192:193], v9 offset:0
    v_mfma_f32_16x16x32_bf16 v[48:51], v[240:243], v[208:211], v[48:51]
    ds_read_b64_tr_b16 v[194:195], v9 offset:1024
    v_mfma_f32_16x16x32_bf16 v[44:47], v[236:239], v[208:211], v[44:47]
    ds_read_b128 v[164:167], v12 offset:4096
    v_mfma_f32_16x16x32_bf16 v[60:63], v[236:239], v[212:215], v[60:63]
    ds_read_b128 v[168:171], v12 offset:6144
    v_mfma_f32_16x16x32_bf16 v[64:67], v[240:243], v[212:215], v[64:67]
    ds_read_b64_tr_b16 v[196:197], v10 offset:0
    v_mfma_f32_16x16x32_bf16 v[68:71], v[244:247], v[212:215], v[68:71]
    ds_read_b64_tr_b16 v[198:199], v10 offset:1024
    v_mfma_f32_16x16x32_bf16 v[72:75], v[248:251], v[212:215], v[72:75]
    ds_read_b128 v[172:175], v12 offset:8192
    v_mfma_f32_16x16x32_bf16 v[88:91], v[248:251], v[216:219], v[88:91]
    ds_read_b128 v[176:179], v12 offset:10240
    v_mfma_f32_16x16x32_bf16 v[84:87], v[244:247], v[216:219], v[84:87]
    ds_read_b64_tr_b16 v[200:201], v11 offset:0
    v_mfma_f32_16x16x32_bf16 v[80:83], v[240:243], v[216:219], v[80:83]
    ds_read_b64_tr_b16 v[202:203], v11 offset:1024
    v_mfma_f32_16x16x32_bf16 v[76:79], v[236:239], v[216:219], v[76:79]
    ds_read_b128 v[180:183], v12 offset:12288
    v_mfma_f32_16x16x32_bf16 v[92:95], v[236:239], v[220:223], v[92:95]
    ds_read_b128 v[184:187], v12 offset:14336
    v_mfma_f32_16x16x32_bf16 v[96:99], v[240:243], v[220:223], v[96:99]
    v_mfma_f32_16x16x32_bf16 v[100:103], v[244:247], v[220:223], v[100:103]
    v_mfma_f32_16x16x32_bf16 v[104:107], v[248:251], v[220:223], v[104:107]
    v_mfma_f32_16x16x32_bf16 v[120:123], v[248:251], v[224:227], v[120:123]
    v_mfma_f32_16x16x32_bf16 v[116:119], v[244:247], v[224:227], v[116:119]
    v_mfma_f32_16x16x32_bf16 v[112:115], v[240:243], v[224:227], v[112:115]
    v_mfma_f32_16x16x32_bf16 v[108:111], v[236:239], v[224:227], v[108:111]
    v_mfma_f32_16x16x32_bf16 v[124:127], v[236:239], v[228:231], v[124:127]
    v_mfma_f32_16x16x32_bf16 v[128:131], v[240:243], v[228:231], v[128:131]
    v_mfma_f32_16x16x32_bf16 v[132:135], v[244:247], v[228:231], v[132:135]
    v_mfma_f32_16x16x32_bf16 v[136:139], v[248:251], v[228:231], v[136:139]
    v_mfma_f32_16x16x32_bf16 v[152:155], v[248:251], v[232:235], v[152:155]
    v_mfma_f32_16x16x32_bf16 v[148:151], v[244:247], v[232:235], v[148:151]
    v_mfma_f32_16x16x32_bf16 v[144:147], v[240:243], v[232:235], v[144:147]
    v_mfma_f32_16x16x32_bf16 v[140:143], v[236:239], v[232:235], v[140:143]
L_gb_mid:
    s_waitcnt lgkmcnt(0)
    v_mfma_f32_16x16x32_bf16 v[28:31], v[188:191], v[156:159], v[28:31]
    ds_read_b64_tr_b16 v[236:237], v8 offset:8192
    s_add_u32 s33, s33, 49152
    v_mfma_f32_16x16x32_bf16 v[32:35], v[192:195], v[156:159], v[32:35]
    ds_read_b64_tr_b16 v[238:239], v8 offset:9216
    s_cmp_eq_u32 s33, 147456
    v_mfma_f32_16x16x32_bf16 v[36:39], v[196:199], v[156:159], v[36:39]
    ds_read_b128 v[204:207], v13 offset:0
    s_cselect_b32 s33, 0, s33
    v_mfma_f32_16x16x32_bf16 v[40:43], v[200:203], v[156:159], v[40:43]
    ds_read_b128 v[208:211], v13 offset:2048
    v_add_u32 v8, s33, v16
    s_sub_u32 s36, s36, 1
    v_mfma_f32_16x16x32_bf16 v[56:59], v[200:203], v[160:163], v[56:59]
    ds_read_b64_tr_b16 v[240:241], v9 offset:8192
    s_cmp_lg_u32 s36, 0
    v_mfma_f32_16x16x32_bf16 v[52:55], v[196:199], v[160:163], v[52:55]
    ds_read_b64_tr_b16 v[242:243], v9 offset:9216
    v_add_u32 v9, s33, v17
    v_mfma_f32_16x16x32_bf16 v[48:51], v[192:195], v[160:163], v[48:51]
    ds_read_b128 v[212:215], v13 offset:4096
    v_mfma_f32_16x16x32_bf16 v[44:47], v[188:191], v[160:163], v[44:47]
    ds_read_b128 v[216:219], v13 offset:6144
    v_mfma_f32_16x16x32_bf16 v[60:63], v[188:191], v[164:167], v[60:63]
    ds_read_b64_tr_b16 v[244:245], v10 offset:8192
    v_mfma_f32_16x16x32_bf16 v[64:67], v[192:195], v[164:167], v[64:67]
    ds_read_b64_tr_b16 v[246:247], v10 offset:9216
    v_add_u32 v10, s33, v18
    v_mfma_f32_16x16x32_bf16 v[68:71], v[196:199], v[164:167], v[68:71]
    ds_read_b128 v[220:223], v13 offset:8192
    v_mfma_f32_16x16x32_bf16 v[72:75], v[200:203], v[164:167], v[72:75]
    ds_read_b128 v[224:227], v13 offset:10240
    v_mfma_f32_16x16x32_bf16 v[88:91], v[200:203], v[168:171], v[88:91]
    ds_read_b64_tr_b16 v[248:249], v11 offset:8192
    v_mfma_f32_16x16x32_bf16 v[84:87], v[196:199], v[168:171], v[84:87]
    ds_read_b64_tr_b16 v[250:251], v11 offset:9216
    v_add_u32 v11, s33, v19
    v_mfma_f32_16x16x32_bf16 v[80:83], v[192:195], v[168:171], v[80:83]
    ds_read_b128 v[228:231], v13 offset:12288
    v_add_u32 v12, s33, v20
    v_mfma_f32_16x16x32_bf16 v[76:79], v[188:191], v[168:171], v[76:79]
    ds_read_b128 v[232:235], v13 offset:14336
    v_add_u32 v13, s33, v21
    v_mfma_f32_16x16x32_bf16 v[92:95], v[188:191], v[172:175], v[92:95]
    v_mfma_f32_16x16x32_bf16 v[96:99], v[192:195], v[172:175], v[96:99]
    v_mfma_f32_16x16x32_bf16 v[100:103], v[196:199], v[172:175], v[100:103]
    v_mfma_f32_16x16x32_bf16 v[104:107], v[200:203], v[172:175], v[104:107]
    v_mfma_f32_16x16x32_bf16 v[120:123], v[200:203], v[176:179], v[120:123]
    v_mfma_f32_16x16x32_bf16 v[116:119], v[196:199], v[176:179], v[116:119]
    v_mfma_f32_16x16x32_bf16 v[112:115], v[192:195], v[176:179], v[112:115]
    v_mfma_f32_16x16x32_bf16 v[108:111], v[188:191], v[176:179], v[108:111]
    v_mfma_f32_16x16x32_bf16 v[124:127], v[188:191], v[180:183], v[124:127]
    v_mfma_f32_16x16x32_bf16 v[128:131], v[192:195], v[180:183], v[128:131]
    v_mfma_f32_16x16x32_bf16 v[132:135], v[196:199], v[180:183], v[132:135]
    v_mfma_f32_16x16x32_bf16 v[136:139], v[200:203], v[180:183], v[136:139]
    v_mfma_f32_16x16x32_bf16 v[152:155], v[200:203], v[184:187], v[152:155]
    v_mfma_f32_16x16x32_bf16 v[148:151], v[196:199], v[184:187], v[148:151]
    v_mfma_f32_16x16x32_bf16 v[144:147], v[192:195], v[184:187], v[144:147]
    v_mfma_f32_16x16x32_bf16 v[140:143], v[188:191], v[184:187], v[140:143]
    s_waitcnt vmcnt(0) lgkmcnt(0)
    s_cbranch_scc1 L_gb_top
    v_mfma_f32_16x16x32_bf16 v[28:31], v[236:239], v[204:207], v[28:31]
    v_mfma_f32_16x16x32_bf16 v[32:35], v[240:243], v[204:207], v[32:35]
    v_mfma_f32_16x16x32_bf16 v[36:39], v[244:247], v[204:207], v[36:39]
    v_mfma_f32_16x16x32_bf16 v[40:43], v[248:251], v[204:207], v[40:43]
    v_mfma_f32_16x16x32_bf16 v[56:59], v[248:251], v[208:211], v[56:59]
    v_mfma_f32_16x16x32_bf16 v[52:55], v[244:247], v[208:211], v[52:55]
    v_mfma_f32_16x16x32_bf16 v[48:51], v[240:243], v[208:211], v[48:51]
    v_mfma_f32_16x16x32_bf16 v[44:47], v[236:239], v[208:211], v[44:47]
    v_mfma_f32_16x16x32_bf16 v[60:63], v[236:239], v[212:215], v[60:63]
    v_mfma_f32_16x16x32_bf16 v[64:67], v[240:243], v[212:215], v[64:67]
    v_mfma_f32_16x16x32_bf16 v[68:71], v[244:247], v[212:215], v[68:71]
    v_mfma_f32_16x16x32_bf16 v[72:75], v[248:251], v[212:215], v[72:75]
    v_mfma_f32_16x16x32_bf16 v[88:91], v[248:251], v[216:219], v[88:91]
    v_mfma_f32_16x16x32_bf16 v[84:87], v[244:247], v[216:219], v[84:87]
    v_mfma_f32_16x16x32_bf16 v[80:83], v[240:243], v[216:219], v[80:83]
    v_mfma_f32_16x16x32_bf16 v[76:79], v[236:239], v[216:219], v[76:79]
    v_mfma_f32_16x16x32_bf16 v[92:95], v[236:239], v[220:223], v[92:95]
    v_mfma_f32_16x16x32_bf16 v[96:99], v[240:243], v[220:223], v[96:99]
    v_mfma_f32_16x16x32_bf16 v[100:103], v[244:247], v[220:223], v[100:103]
    v_mfma_f32_16x16x32_bf16 v[104:107], v[248:251], v[220:223], v[104:107]
    v_mfma_f32_16x16x32_bf16 v[120:123], v[248:251], v[224:227], v[120:123]
    v_mfma_f32_16x16x32_bf16 v[116:119], v[244:247], v[224:227], v[116:119]
    v_mfma_f32_16x16x32_bf16 v[112:115], v[240:243], v[224:227], v[112:115]
    v_mfma_f32_16x16x32_bf16 v[108:111], v[236:239], v[224:227], v[108:111]
    v_mfma_f32_16x16x32_bf16 v[124:127], v[236:239], v[228:231], v[124:127]
    v_mfma_f32_16x16x32_bf16 v[128:131], v[240:243], v[228:231], v[128:131]
    v_mfma_f32_16x16x32_bf16 v[132:135], v[244:247], v[228:231], v[132:135]
    v_mfma_f32_16x16x32_bf16 v[136:139], v[248:251], v[228:231], v[136:139]
    v_mfma_f32_16x16x32_bf16 v[152:155], v[248:251], v[232:235], v[152:155]
    v_mfma_f32_16x16x32_bf16 v[148:151], v[244:247], v[232:235], v[148:151]
    v_mfma_f32_16x16x32_bf16 v[144:147], v[240:243], v[232:235], v[144:147]
    v_mfma_f32_16x16x32_bf16 v[140:143], v[236:239], v[232:235], v[140:143]
    s_lshl_b32 s40, s22, 5
    s_lshl_b32 s41, s23, 2
    s_add_u32 s40, s40, s41
    s_lshl_b32 s41, s31, 1
    s_add_u32 s40, s40, s41
    s_lshl_b32 s40, s40, 14
    s_lshl_b32 s41, s30, 13
    s_add_u32 s40, s40, s41
    s_add_u32 s41, s40, 4096
    s_add_u32 s42, s40, 16384
    s_add_u32 s43, s40, 20480
    v_lshlrev_b32 v3, 4, v2
    v_cvt_pk_bf16_f32 v156, v28, v29
    v_cvt_pk_bf16_f32 v157, v30, v31
    v_cvt_pk_bf16_f32 v158, v32, v33
    v_cvt_pk_bf16_f32 v159, v34, v35
    buffer_store_dwordx4 v[156:159], v3, s[16:19], s40 offen offset:0 sc1
    v_cvt_pk_bf16_f32 v160, v44, v45
    v_cvt_pk_bf16_f32 v161, v46, v47
    v_cvt_pk_bf16_f32 v162, v48, v49
    v_cvt_pk_bf16_f32 v163, v50, v51
    buffer_store_dwordx4 v[160:163], v3, s[16:19], s40 offen offset:1024 sc1
    v_cvt_pk_bf16_f32 v164, v60, v61
    v_cvt_pk_bf16_f32 v165, v62, v63
    v_cvt_pk_bf16_f32 v166, v64, v65
    v_cvt_pk_bf16_f32 v167, v66, v67
    buffer_store_dwordx4 v[164:167], v3, s[16:19], s40 offen offset:2048 sc1
    v_cvt_pk_bf16_f32 v168, v76, v77
    v_cvt_pk_bf16_f32 v169, v78, v79
    v_cvt_pk_bf16_f32 v170, v80, v81
    v_cvt_pk_bf16_f32 v171, v82, v83
    buffer_store_dwordx4 v[168:171], v3, s[16:19], s40 offen offset:3072 sc1
    v_cvt_pk_bf16_f32 v172, v92, v93
    v_cvt_pk_bf16_f32 v173, v94, v95
    v_cvt_pk_bf16_f32 v174, v96, v97
    v_cvt_pk_bf16_f32 v175, v98, v99
    buffer_store_dwordx4 v[172:175], v3, s[16:19], s41 offen offset:0 sc1
    v_cvt_pk_bf16_f32 v176, v108, v109
    v_cvt_pk_bf16_f32 v177, v110, v111
    v_cvt_pk_bf16_f32 v178, v112, v113
    v_cvt_pk_bf16_f32 v179, v114, v115
    buffer_store_dwordx4 v[176:179], v3, s[16:19], s41 offen offset:1024 sc1
    v_cvt_pk_bf16_f32 v180, v124, v125
    v_cvt_pk_bf16_f32 v181, v126, v127
    v_cvt_pk_bf16_f32 v182, v128, v129
    v_cvt_pk_bf16_f32 v183, v130, v131
    buffer_store_dwordx4 v[180:183], v3, s[16:19], s41 offen offset:2048 sc1
    v_cvt_pk_bf16_f32 v184, v140, v141
    v_cvt_pk_bf16_f32 v185, v142, v143
    v_cvt_pk_bf16_f32 v186, v144, v145
    v_cvt_pk_bf16_f32 v187, v146, v147
    buffer_store_dwordx4 v[184:187], v3, s[16:19], s41 offen offset:3072 sc1
    v_cvt_pk_bf16_f32 v188, v36, v37
    v_cvt_pk_bf16_f32 v189, v38, v39
    v_cvt_pk_bf16_f32 v190, v40, v41
    v_cvt_pk_bf16_f32 v191, v42, v43
    buffer_store_dwordx4 v[188:191], v3, s[16:19], s42 offen offset:0 sc1
    v_cvt_pk_bf16_f32 v192, v52, v53
    v_cvt_pk_bf16_f32 v193, v54, v55
    v_cvt_pk_bf16_f32 v194, v56, v57
    v_cvt_pk_bf16_f32 v195, v58, v59
    buffer_store_dwordx4 v[192:195], v3, s[16:19], s42 offen offset:1024 sc1
    v_cvt_pk_bf16_f32 v196, v68, v69
    v_cvt_pk_bf16_f32 v197, v70, v71
    v_cvt_pk_bf16_f32 v198, v72, v73
    v_cvt_pk_bf16_f32 v199, v74, v75
    buffer_store_dwordx4 v[196:199], v3, s[16:19], s42 offen offset:2048 sc1
    v_cvt_pk_bf16_f32 v200, v84, v85
    v_cvt_pk_bf16_f32 v201, v86, v87
    v_cvt_pk_bf16_f32 v202, v88, v89
    v_cvt_pk_bf16_f32 v203, v90, v91
    buffer_store_dwordx4 v[200:203], v3, s[16:19], s42 offen offset:3072 sc1
    v_cvt_pk_bf16_f32 v204, v100, v101
    v_cvt_pk_bf16_f32 v205, v102, v103
    v_cvt_pk_bf16_f32 v206, v104, v105
    v_cvt_pk_bf16_f32 v207, v106, v107
    buffer_store_dwordx4 v[204:207], v3, s[16:19], s43 offen offset:0 sc1
    v_cvt_pk_bf16_f32 v208, v116, v117
    v_cvt_pk_bf16_f32 v209, v118, v119
    v_cvt_pk_bf16_f32 v210, v120, v121
    v_cvt_pk_bf16_f32 v211, v122, v123
    buffer_store_dwordx4 v[208:211], v3, s[16:19], s43 offen offset:1024 sc1
    v_cvt_pk_bf16_f32 v212, v132, v133
    v_cvt_pk_bf16_f32 v213, v134, v135
    v_cvt_pk_bf16_f32 v214, v136, v137
    v_cvt_pk_bf16_f32 v215, v138, v139
    buffer_store_dwordx4 v[212:215], v3, s[16:19], s43 offen offset:2048 sc1
    v_cvt_pk_bf16_f32 v216, v148, v149
    v_cvt_pk_bf16_f32 v217, v150, v151
    v_cvt_pk_bf16_f32 v218, v152, v153
    v_cvt_pk_bf16_f32 v219, v154, v155
    buffer_store_dwordx4 v[216:219], v3, s[16:19], s43 offen offset:3072 sc1
    s_xor_b32 s23, s23, 1
    s_add_u32 s53, s53, 1
    s_cmp_lt_u32 s53, 2
    s_cbranch_scc1 L_bl
    s_waitcnt vmcnt(0)
    s_barrier
    s_endpgm
L_pb:
    s_sub_u32 s30, s25, 4
    s_lshl_b32 s31, s30, 10
    s_lshl_b32 s32, s30, 12
    v_lshrrev_b32 v3, 4, v2
    v_and_b32 v4, 15, v2
    s_and_b32 s26, s30, 2
    s_lshl_b32 s26, s26, 1
    v_or_b32 v5, s26, v3
    v_lshlrev_b32 v5, 1, v5
    v_xor_b32 v5, v5, v4
    v_lshlrev_b32 v5, 4, v5
    s_lshl_b32 s26, s30, 2
    v_add_u32 v6, s26, v3
    v_mul_u32_u24 v6, 2048, v6
    v_add_u32 v5, v5, v6
    v_mov_b32 v8, v5
    s_and_b32 s26, s30, 1
    s_lshl_b32 s26, s26, 2
    v_or_b32 v5, s26, v3
    v_and_b32 v6, 7, v2
    v_xor_b32 v5, v5, v6
    v_lshlrev_b32 v5, 4, v5
    s_lshl_b32 s26, s30, 3
    v_lshrrev_b32 v6, 3, v2
    v_add_u32 v6, s26, v6
    v_lshlrev_b32 v6, 11, v6
    v_add_u32 v9, v5, v6
    s_lshl_b32 s27, s22, 10
    s_lshl_b32 s26, s23, 7
    s_add_u32 s27, s27, s26
    s_add_u32 s27, s27, 57344
    s_mov_b32 s36, 0
    s_and_b32 s34, s36, 15
    s_sub_u32 s38, s34, s24
    s_and_b32 s38, s38, 3
    s_cmp_le_u32 s38, 2
    s_cselect_b32 s39, -1, 0
    s_cmp_eq_u32 s38, 0
    s_cselect_b32 s39, 2, s39
    s_cmp_lt_u32 s34, s24
    s_cselect_b32 s39, 0, s39
    s_sub_u32 s38, s34, s38
    s_cmp_ge_i32 s38, 13
    s_cselect_b32 s39, 0, s39
    s_add_u32 s37, s34, s39
    s_lshl_b32 s38, s20, 1
    s_add_u32 s37, s37, s38
    s_and_b32 s37, s37, 15
    s_lshr_b32 s38, s36, 4
    s_xor_b32 s38, s38, s23
    s_lshl_b32 s38, s38, 8
    s_lshl_b32 s45, s37, 17
    s_add_u32 s45, s45, s38
    s_lshl_b32 s38, s22, 19
    s_lshl_b32 s46, s37, 7
    s_add_u32 s46, s46, s38
    s_add_u32 s44, s33, s31
    s_add_u32 m0, s44, 0
    s_nop 0
    buffer_load_dwordx4 v8, s[8:11], s45 offen lds
    s_add_u32 m0, s44, 4096
    s_add_u32 s45, s45, 32768
    buffer_load_dwordx4 v8, s[8:11], s45 offen lds
    s_add_u32 m0, s44, 8192
    s_add_u32 s45, s45, 32768
    buffer_load_dwordx4 v8, s[8:11], s45 offen lds
    s_add_u32 m0, s44, 12288
    s_add_u32 s45, s45, 32768
    buffer_load_dwordx4 v8, s[8:11], s45 offen lds
    s_add_u32 m0, s44, 16384
    s_nop 0
    buffer_load_dwordx4 v9, s[12:15], s46 offen lds
    s_add_u32 m0, s44, 20480
    s_add_u32 s46, s46, 65536
    buffer_load_dwordx4 v9, s[12:15], s46 offen lds
    s_add_u32 m0, s44, 24576
    s_add_u32 s46, s46, 65536
    buffer_load_dwordx4 v9, s[12:15], s46 offen lds
    s_add_u32 m0, s44, 28672
    s_add_u32 s46, s46, 65536
    buffer_load_dwordx4 v9, s[12:15], s46 offen lds
    s_add_u32 m0, s44, 32768
    s_add_u32 s46, s46, 65536
    buffer_load_dwordx4 v9, s[12:15], s46 offen lds
    s_add_u32 m0, s44, 36864
    s_add_u32 s46, s46, 65536
    buffer_load_dwordx4 v9, s[12:15], s46 offen lds
    s_add_u32 m0, s44, 40960
    s_add_u32 s46, s46, 65536
    buffer_load_dwordx4 v9, s[12:15], s46 offen lds
    s_add_u32 m0, s44, 45056
    s_add_u32 s46, s46, 65536
    buffer_load_dwordx4 v9, s[12:15], s46 offen lds
    s_add_u32 s33, s33, 49152
    s_cmp_eq_u32 s33, 147456
    s_cselect_b32 s33, 0, s33
    s_add_u32 s36, s36, 1
    s_and_b32 s34, s36, 15
    s_sub_u32 s38, s34, s24
    s_and_b32 s38, s38, 3
    s_cmp_le_u32 s38, 2
    s_cselect_b32 s39, -1, 0
    s_cmp_eq_u32 s38, 0
    s_cselect_b32 s39, 2, s39
    s_cmp_lt_u32 s34, s24
    s_cselect_b32 s39, 0, s39
    s_sub_u32 s38, s34, s38
    s_cmp_ge_i32 s38, 13
    s_cselect_b32 s39, 0, s39
    s_add_u32 s37, s34, s39
    s_lshl_b32 s38, s20, 1
    s_add_u32 s37, s37, s38
    s_and_b32 s37, s37, 15
    s_lshr_b32 s38, s36, 4
    s_xor_b32 s38, s38, s23
    s_lshl_b32 s38, s38, 8
    s_lshl_b32 s45, s37, 17
    s_add_u32 s45, s45, s38
    s_lshl_b32 s38, s22, 19
    s_lshl_b32 s46, s37, 7
    s_add_u32 s46, s46, s38
    s_add_u32 s44, s33, s31
    s_add_u32 m0, s44, 0
    s_nop 0
    buffer_load_dwordx4 v8, s[8:11], s45 offen lds
    s_add_u32 m0, s44, 4096
    s_add_u32 s45, s45, 32768
    buffer_load_dwordx4 v8, s[8:11], s45 offen lds
    s_add_u32 m0, s44, 8192
    s_add_u32 s45, s45, 32768
    buffer_load_dwordx4 v8, s[8:11], s45 offen lds
    s_add_u32 m0, s44, 12288
    s_add_u32 s45, s45, 32768
    buffer_load_dwordx4 v8, s[8:11], s45 offen lds
    s_add_u32 m0, s44, 16384
    s_nop 0
    buffer_load_dwordx4 v9, s[12:15], s46 offen lds
    s_add_u32 m0, s44, 20480
    s_add_u32 s46, s46, 65536
    buffer_load_dwordx4 v9, s[12:15], s46 offen lds
    s_add_u32 m0, s44, 24576
    s_add_u32 s46, s46, 65536
    buffer_load_dwordx4 v9, s[12:15], s46 offen lds
    s_add_u32 m0, s44, 28672
    s_add_u32 s46, s46, 65536
    buffer_load_dwordx4 v9, s[12:15], s46 offen lds
    s_add_u32 m0, s44, 32768
    s_add_u32 s46, s46, 65536
    buffer_load_dwordx4 v9, s[12:15], s46 offen lds
    s_add_u32 m0, s44, 36864
    s_add_u32 s46, s46, 65536
    buffer_load_dwordx4 v9, s[12:15], s46 offen lds
    s_add_u32 m0, s44, 40960
    s_add_u32 s46, s46, 65536
    buffer_load_dwordx4 v9, s[12:15], s46 offen lds
    s_add_u32 m0, s44, 45056
    s_add_u32 s46, s46, 65536
    buffer_load_dwordx4 v9, s[12:15], s46 offen lds
    s_add_u32 s33, s33, 49152
    s_cmp_eq_u32 s33, 147456
    s_cselect_b32 s33, 0, s33
    s_add_u32 s36, s36, 1
    s_waitcnt lgkmcnt(0)
    s_mul_i32 s4, s6, 0x9e3779b1
    s_add_u32 s4, s4, 0x7f4a7c15
    s_mul_i32 s5, s7, 0x85ebca6b
    s_add_u32 s5, s5, 0xc2b2ae35
L_gb_ptop:
    s_and_b32 s34, s36, 15
    s_sub_u32 s38, s34, s24
    s_and_b32 s38, s38, 3
    s_cmp_le_u32 s38, 2
    s_cselect_b32 s39, -1, 0
    s_cmp_eq_u32 s38, 0
    s_cselect_b32 s39, 2, s39
    s_cmp_lt_u32 s34, s24
    s_cselect_b32 s39, 0, s39
    s_sub_u32 s38, s34, s38
    s_cmp_ge_i32 s38, 13
    s_cselect_b32 s39, 0, s39
    s_add_u32 s37, s34, s39
    s_lshl_b32 s38, s20, 1
    s_add_u32 s37, s37, s38
    s_and_b32 s37, s37, 15
    s_lshr_b32 s38, s36, 4
    s_xor_b32 s38, s38, s23
    s_lshl_b32 s38, s38, 8
    s_lshl_b32 s45, s37, 17
    s_add_u32 s45, s45, s38
    s_lshl_b32 s38, s22, 19
    s_lshl_b32 s46, s37, 7
    s_add_u32 s46, s46, s38
    s_waitcnt vmcnt(12)
    s_barrier
    s_xor_b32 s26, s36, 19
    s_or_b32 s26, s26, s30
    s_cmp_lg_u32 s26, 0
    s_cbranch_scc1 L_pb_nf
    v_mov_b32 v24, s4
    v_mov_b32 v25, s5
    v_mov_b32 v26, 0
    s_mov_b64 exec, 1
    buffer_store_dwordx2 v[24:25], v26, s[48:51], s27 offen offset:0 sc1
    s_mov_b64 exec, -1
L_pb_nf:
    s_add_u32 s44, s33, s31
    s_add_u32 m0, s44, 0
    s_nop 0
    buffer_load_dwordx4 v8, s[8:11], s45 offen lds
    s_add_u32 m0, s44, 4096
    s_add_u32 s45, s45, 32768
    buffer_load_dwordx4 v8, s[8:11], s45 offen lds
    s_add_u32 m0, s44, 8192
    s_add_u32 s45, s45, 32768
    buffer_load_dwordx4 v8, s[8:11], s45 offen lds
    s_add_u32 m0, s44, 12288
    s_add_u32 s45, s45, 32768
    buffer_load_dwordx4 v8, s[8:11], s45 offen lds
    s_add_u32 m0, s44, 16384
    s_nop 0
    buffer_load_dwordx4 v9, s[12:15], s46 offen lds
    s_add_u32 m0, s44, 20480
    s_add_u32 s46, s46, 65536
    buffer_load_dwordx4 v9, s[12:15], s46 offen lds
    s_add_u32 m0, s44, 24576
    s_add_u32 s46, s46, 65536
    buffer_load_dwordx4 v9, s[12:15], s46 offen lds
    s_add_u32 m0, s44, 28672
    s_add_u32 s46, s46, 65536
    buffer_load_dwordx4 v9, s[12:15], s46 offen lds
    s_add_u32 m0, s44, 32768
    s_add_u32 s46, s46, 65536
    buffer_load_dwordx4 v9, s[12:15], s46 offen lds
    s_add_u32 m0, s44, 36864
    s_add_u32 s46, s46, 65536
    buffer_load_dwordx4 v9, s[12:15], s46 offen lds
    s_add_u32 m0, s44, 40960
    s_add_u32 s46, s46, 65536
    buffer_load_dwordx4 v9, s[12:15], s46 offen lds
    s_add_u32 m0, s44, 45056
    s_add_u32 s46, s46, 65536
    buffer_load_dwordx4 v9, s[12:15], s46 offen lds
    s_add_u32 s33, s33, 49152
    s_cmp_eq_u32 s33, 147456
    s_cselect_b32 s33, 0, s33
    s_add_u32 s36, s36, 1
    s_cmp_lt_u32 s36, 32
    s_cbranch_scc1 L_gb_ptop
    s_waitcnt vmcnt(12)
    s_barrier
    s_waitcnt vmcnt(0)
    s_barrier
    s_barrier
    s_cmp_lg_u32 s30, 0
    s_cbranch_scc1 L_pb_end
    s_xor_b32 s27, s27, 128
    v_mov_b32 v24, s4
    v_mov_b32 v25, s5
    v_mov_b32 v26, 0
    s_mov_b64 exec, 1
    buffer_store_dwordx2 v[24:25], v26, s[48:51], s27 offen offset:0 sc1
    s_mov_b64 exec, -1
L_pb_end:
    s_endpgm
L_end:
    s_endpgm
L_code_end:
.section .rodata,"a"
.p2align 6
.amdhsa_kernel standalone__weight_only_int_quip__prompt_kernel
.amdhsa_next_free_vgpr 256
.amdhsa_next_free_sgpr 96
.amdhsa_accum_offset 256
.amdhsa_group_segment_fixed_size 0
.amdhsa_kernarg_size 72
.amdhsa_user_sgpr_count 2
.amdhsa_user_sgpr_kernarg_segment_ptr 1
.amdhsa_system_sgpr_workgroup_id_x 1
.amdhsa_float_denorm_mode_32 3
.end_amdhsa_kernel
```
